```python
import torch

def _softmax(x, axis=-1):
    return torch.softmax(x, dim=axis)
def _gelu(x):
    return torch.nn.functional.gelu(x, approximate="tanh")
def _silu(x):
    return torch.nn.functional.silu(x)
def _sigmoid(x):
    return torch.sigmoid(x)
def _layernorm(x, axis=-1, eps=1e-5):
    m = x.mean(dim=axis, keepdim=True)
    v = x.var(dim=axis, keepdim=True, unbiased=False)
    return (x - m) / torch.sqrt(v + eps)
def _scatter_add(tgt, idx, src, axis=0):
    return tgt.clone().index_add_(axis, idx, src)
def _segment_sum(src, seg, n):
    out = torch.zeros((n,) + src.shape[1:], dtype=src.dtype)
    return out.index_add_(0, seg, src)
def _pad(x, pw):
    flat = tuple(v for pair in reversed(pw) for v in pair)
    return torch.nn.functional.pad(x, flat)

kernel_name = 'parallel_sum__sliding_block_cached__glu_gated_reglu__decode'

def setup_inputs():

    _w = (lambda a: (lambda t: t.to(torch.bfloat16) if t.is_floating_point() else t)(torch.as_tensor(a)))
    def _A_setup():
        B, Sq, D = 2, 1, 448
        Hq, Hkv, Sk, Dh = 16, 8, 32768, 256
        assert Hq % Hkv == 0, (Hq, Hkv)
        return {
            "x": _w((lambda *s: torch.randn(*s, dtype=torch.bfloat16) * 0.05)(B, Sq, D)),
            "k_cache": _w((lambda *s: torch.randn(*s, dtype=torch.bfloat16) * 1.6)(B, Hkv, Sk, Dh)),
            "v_cache": _w((lambda *s: torch.randn(*s, dtype=torch.bfloat16) * 0.8)(B, Hkv, Sk, Dh)),
            "wq": _w((lambda *s: torch.randn(*s, dtype=torch.bfloat16) * 1.6)(D, Hq * Dh) * (D ** -0.5)),
            "wo": _w((lambda *s: torch.randn(*s, dtype=torch.bfloat16) * 0.8)(Hq * Dh, D) * ((Hq * Dh) ** -0.5)),
        }
    _A_in = _A_setup()

    def _B_setup():
        B, S, D, F = 2, 1, 448, 1792
        return {
            "x": _w((lambda *s: torch.randn(*s, dtype=torch.bfloat16) * 0.05)(B, S, D)),
            "W_gate": _w((lambda *s: torch.randn(*s, dtype=torch.bfloat16) * 0.4)(D, F) * (2.0 / D) ** 0.5),
            "W_up": _w((lambda *s: torch.randn(*s, dtype=torch.bfloat16) * 0.4)(D, F) * (2.0 / D) ** 0.5),
            "W_down": _w((lambda *s: torch.randn(*s, dtype=torch.bfloat16) * 0.4)(F, D) * (1.0 / F) ** 0.5),
        }
    _B_in = _B_setup()

    return {
        "A_x": _A_in["x"],
        "A_k_cache": _A_in["k_cache"],
        "A_v_cache": _A_in["v_cache"],
        "A_wq": _A_in["wq"],
        "A_wo": _A_in["wo"],
        "B_x": _B_in["x"],
        "B_W_gate": _B_in["W_gate"],
        "B_W_up": _B_in["W_up"],
        "B_W_down": _B_in["W_down"],
    }

def reference(A_x, A_k_cache, A_v_cache, A_wq, A_wo, B_x, B_W_gate, B_W_up, B_W_down):
    def _A_ref(x, k_cache, v_cache, wq, wo):
        B, Sq, D = x.shape
        Hq, Dh = 16, 256
        Hkv, Sk = k_cache.shape[1], k_cache.shape[2]
        W = min(4096, max(256, Sk // 4))
        rep = Hq // Hkv
        q = (lambda x, *d: x.permute(*d))((x @ wq).reshape(B, Sq, Hq, Dh), 0, 2, 1, 3)
        k = (lambda x, n, axis: torch.repeat_interleave(x, n, dim=axis))(k_cache[:, :, Sk - W:, :], rep, axis=1)
        v = (lambda x, n, axis: torch.repeat_interleave(x, n, dim=axis))(v_cache[:, :, Sk - W:, :], rep, axis=1)
        scores = torch.einsum("bhqd,bhkd->bhqk", q, k) * (Dh ** -0.5)
        p = _softmax(scores, axis=-1)
        o = torch.einsum("bhqk,bhkd->bhqd", p, v)
        return (lambda x, *d: x.permute(*d))(o, 0, 2, 1, 3).reshape(B, Sq, Hq * Dh) @ wo

    def _B_ref(x, W_gate, W_up, W_down):
        gate = torch.einsum("bsd,df->bsf", x, W_gate)
        up = torch.einsum("bsd,df->bsf", x, W_up)
        gate = gate * (lambda x, dt: x.to(dt))(gate > 0, gate.dtype)
        h = gate * up
        return torch.einsum("bsf,fd->bsd", h, W_down)

    x = A_x
    xn = _layernorm(x, axis=-1)
    return x + _A_ref(xn, A_k_cache, A_v_cache, A_wq, A_wo) + _B_ref(xn, B_W_gate, B_W_up, B_W_down)
```

```asm
; @launch grid=(256,1,1) block=(512,1,1) lds=162768
.amdgcn_target "amdgcn-amd-amdhsa--gfx950"
.text
.globl parallel_sum__sliding_block_cached__glu_gated_reglu__decode_kernel
.p2align 8
.type parallel_sum__sliding_block_cached__glu_gated_reglu__decode_kernel,@function
parallel_sum__sliding_block_cached__glu_gated_reglu__decode_kernel:
    s_load_dwordx16 s[4:19], s[0:1], 0
    v_lshrrev_b32 v2, 6, v0
    v_and_b32 v1, 63, v0
    s_lshr_b32 s29, s2, 3
    v_readfirstlane_b32 s3, v2
    s_and_b32 s28, s2, 7

    s_cmp_ge_u32 s29, 32
    s_cbranch_scc1 L_end
    s_cmp_ge_u32 s3, 2
    s_cbranch_scc1 L_nh
    v_min_u32 v2, 55, v1
    v_lshrrev_b32 v6, 3, v1
    v_lshlrev_b32 v2, 4, v2
    v_and_b32 v7, 7, v1
    v_and_b32 v8, 6, v6
    v_xor_b32 v7, v7, v8
    s_and_b32 s31, s29, 7
    s_lshr_b32 s33, s29, 3
    s_cmp_gt_u32 s28, 5
    s_subb_u32 s30, s28, 0
    s_lshl2_add_u32 s30, s30, s33
    s_lshl3_add_u32 s35, s28, s31
    s_lshl_b32 s33, s33, 1
    s_cmp_lg_u32 s28, 5
    s_cselect_b32 s43, 3584, 0
    s_cmp_eq_u32 s3, 0
    s_cselect_b32 s34, s33, s31
    s_cselect_b32 s35, s35, s30
    s_cselect_b32 s43, 8192, s43
    s_cselect_b32 s52, 65536, 0
    s_mul_i32 m0, s3, 14336
    s_mul_i32 s40, s34, 56
    s_bitset1_b32 m0, 17
    v_add_u32 v6, s40, v6
    v_lshl_add_u32 v7, s35, 3, v7
    v_mul_u32_u24 v6, s43, v6
    s_mul_i32 s43, s43, 8
    v_lshl_add_u32 v6, v7, 4, v6
    s_movk_i32 s33, 6
    s_waitcnt lgkmcnt(0)
    s_cselect_b64 s[36:37], s[10:11], s[16:17]
    s_cselect_b64 s[48:49], s[10:11], s[18:19]
    global_load_dwordx4 v[16:19], v2, s[4:5]
    global_load_dwordx4 v[20:23], v2, s[4:5] offset:896
L_hw:
    global_load_lds_dwordx4 v6, s[36:37] nt
    s_addk_i32 m0, 1024
    v_add_u32 v6, s52, v6
    global_load_lds_dwordx4 v6, s[48:49] nt
    s_addk_i32 m0, 1024
    v_add_u32 v6, s43, v6
    s_sub_u32 s33, s33, 1
    s_cbranch_scc0 L_hw
    s_barrier
    s_setprio 3
    s_load_dwordx8 s[20:27], s[0:1], 64
    s_mul_i32 s41, s3, 14336
    s_bitset1_b32 s41, 17
    s_add_u32 s3, s3, 4
    s_lshl_b32 s40, s40, 1
    v_lshrrev_b32 v4, 4, v1
    v_lshlrev_b32 v3, 4, v1
    v_mov_b32 v24, 0
    v_lshlrev_b32 v25, 1, v1
    v_add_u32 v25, 162560, v25
    ds_write_b16 v25, v24
    v_cmp_gt_u32 vcc, 56, v1
    s_waitcnt vmcnt(14)
    v_lshlrev_b32 v24, 16, v16
    v_and_b32 v25, 0xffff0000, v16
    v_lshlrev_b32 v26, 16, v17
    v_and_b32 v27, 0xffff0000, v17
    v_lshlrev_b32 v28, 16, v18
    v_and_b32 v29, 0xffff0000, v18
    v_lshlrev_b32 v30, 16, v19
    v_and_b32 v31, 0xffff0000, v19
    v_lshlrev_b32 v32, 16, v20
    v_and_b32 v33, 0xffff0000, v20
    v_lshlrev_b32 v34, 16, v21
    v_and_b32 v35, 0xffff0000, v21
    v_lshlrev_b32 v36, 16, v22
    v_and_b32 v37, 0xffff0000, v22
    v_lshlrev_b32 v38, 16, v23
    v_and_b32 v39, 0xffff0000, v23
    v_add_f32 v40, v24, v25
    v_add_f32 v41, v32, v33
    v_add_f32 v40, v40, v26
    v_add_f32 v40, v40, v27
    v_add_f32 v41, v41, v34
    v_add_f32 v41, v41, v35
    v_add_f32 v40, v40, v28
    v_add_f32 v40, v40, v29
    v_add_f32 v41, v41, v36
    v_add_f32 v41, v41, v37
    v_add_f32 v40, v40, v30
    v_add_f32 v40, v40, v31
    v_add_f32 v41, v41, v38
    v_add_f32 v41, v41, v39
    v_cndmask_b32 v40, 0, v40, vcc
    v_cndmask_b32 v41, 0, v41, vcc
    s_waitcnt lgkmcnt(0)
    s_load_dword s60, s[26:27], 0
    s_mov_b32 s44, s26
    s_mov_b32 s45, s27
    s_mov_b32 s46, 1155072
    s_mov_b32 s47, 0x20000
    s_movk_i32 s62, 1023
    v_add_f32_dpp v40, v40, v40 row_ror:8 row_mask:0xf bank_mask:0xf
    v_add_f32_dpp v41, v41, v41 row_ror:8 row_mask:0xf bank_mask:0xf
    s_nop 0
    v_add_f32_dpp v40, v40, v40 row_ror:4 row_mask:0xf bank_mask:0xf
    v_add_f32_dpp v41, v41, v41 row_ror:4 row_mask:0xf bank_mask:0xf
    s_nop 0
    v_add_f32_dpp v40, v40, v40 row_ror:2 row_mask:0xf bank_mask:0xf
    v_add_f32_dpp v41, v41, v41 row_ror:2 row_mask:0xf bank_mask:0xf
    s_nop 0
    v_add_f32_dpp v40, v40, v40 row_ror:1 row_mask:0xf bank_mask:0xf
    v_add_f32_dpp v41, v41, v41 row_ror:1 row_mask:0xf bank_mask:0xf
    v_mov_b32 v42, v40
    v_mov_b32 v43, v41
    s_nop 0
    v_permlane16_swap_b32 v42, v40
    v_permlane16_swap_b32 v43, v41
    v_add_f32 v40, v40, v42
    v_add_f32 v41, v41, v43
    v_mov_b32 v42, v40
    v_mov_b32 v43, v41
    s_nop 0
    v_permlane32_swap_b32 v42, v40
    v_permlane32_swap_b32 v43, v41
    v_add_f32 v40, v40, v42
    v_add_f32 v41, v41, v43
    s_mov_b32 s34, 0x3b124925
    v_mul_f32 v40, s34, v40
    v_mul_f32 v41, s34, v41
    v_sub_f32 v46, v24, v40
    v_sub_f32 v47, v32, v41
    v_mul_f32 v44, v46, v46
    v_mul_f32 v45, v47, v47
    v_sub_f32 v46, v25, v40
    v_sub_f32 v47, v33, v41
    v_fmac_f32 v44, v46, v46
    v_fmac_f32 v45, v47, v47
    v_sub_f32 v46, v26, v40
    v_sub_f32 v47, v34, v41
    v_fmac_f32 v44, v46, v46
    v_fmac_f32 v45, v47, v47
    v_sub_f32 v46, v27, v40
    v_sub_f32 v47, v35, v41
    v_fmac_f32 v44, v46, v46
    v_fmac_f32 v45, v47, v47
    v_sub_f32 v46, v28, v40
    v_sub_f32 v47, v36, v41
    v_fmac_f32 v44, v46, v46
    v_fmac_f32 v45, v47, v47
    v_sub_f32 v46, v29, v40
    v_sub_f32 v47, v37, v41
    v_fmac_f32 v44, v46, v46
    v_fmac_f32 v45, v47, v47
    v_sub_f32 v46, v30, v40
    v_sub_f32 v47, v38, v41
    v_fmac_f32 v44, v46, v46
    v_fmac_f32 v45, v47, v47
    v_sub_f32 v46, v31, v40
    v_sub_f32 v47, v39, v41
    v_fmac_f32 v44, v46, v46
    v_fmac_f32 v45, v47, v47
    v_cndmask_b32 v44, 0, v44, vcc
    v_cndmask_b32 v45, 0, v45, vcc
    s_nop 0
    v_add_f32_dpp v44, v44, v44 row_ror:8 row_mask:0xf bank_mask:0xf
    v_add_f32_dpp v45, v45, v45 row_ror:8 row_mask:0xf bank_mask:0xf
    s_nop 0
    v_add_f32_dpp v44, v44, v44 row_ror:4 row_mask:0xf bank_mask:0xf
    v_add_f32_dpp v45, v45, v45 row_ror:4 row_mask:0xf bank_mask:0xf
    s_nop 0
    v_add_f32_dpp v44, v44, v44 row_ror:2 row_mask:0xf bank_mask:0xf
    v_add_f32_dpp v45, v45, v45 row_ror:2 row_mask:0xf bank_mask:0xf
    s_nop 0
    v_add_f32_dpp v44, v44, v44 row_ror:1 row_mask:0xf bank_mask:0xf
    v_add_f32_dpp v45, v45, v45 row_ror:1 row_mask:0xf bank_mask:0xf
    v_mov_b32 v42, v44
    v_mov_b32 v43, v45
    s_nop 0
    v_permlane16_swap_b32 v42, v44
    v_permlane16_swap_b32 v43, v45
    v_add_f32 v44, v44, v42
    v_add_f32 v45, v45, v43
    v_mov_b32 v42, v44
    v_mov_b32 v43, v45
    s_nop 0
    v_permlane32_swap_b32 v42, v44
    v_permlane32_swap_b32 v43, v45
    v_add_f32 v44, v44, v42
    v_add_f32 v45, v45, v43
    v_mul_f32 v44, s34, v44
    v_mul_f32 v45, s34, v45
    v_cvt_pk_bf16_f32 v40, v40, v41
    v_and_b32 v41, 0xffff0000, v40
    v_lshlrev_b32 v40, 16, v40
    v_cvt_pk_bf16_f32 v44, v44, v45
    v_and_b32 v45, 0xffff0000, v44
    v_lshlrev_b32 v44, 16, v44
    v_add_f32 v44, 0x3727c5ac, v44
    v_add_f32 v45, 0x3727c5ac, v45
    v_cvt_pk_bf16_f32 v44, v44, v45
    v_and_b32 v45, 0xffff0000, v44
    v_lshlrev_b32 v44, 16, v44
    v_sqrt_f32 v44, v44
    v_sqrt_f32 v45, v45
    v_sub_f32 v24, v24, v40
    v_sub_f32 v25, v25, v40
    v_sub_f32 v26, v26, v40
    v_sub_f32 v27, v27, v40
    v_sub_f32 v28, v28, v40
    v_sub_f32 v29, v29, v40
    v_sub_f32 v30, v30, v40
    v_sub_f32 v31, v31, v40
    v_sub_f32 v32, v32, v41
    v_sub_f32 v33, v33, v41
    v_sub_f32 v34, v34, v41
    v_sub_f32 v35, v35, v41
    v_sub_f32 v36, v36, v41
    v_sub_f32 v37, v37, v41
    v_sub_f32 v38, v38, v41
    v_sub_f32 v39, v39, v41
    v_cvt_pk_bf16_f32 v44, v44, v45
    v_and_b32 v45, 0xffff0000, v44
    v_lshlrev_b32 v44, 16, v44
    v_rcp_f32 v44, v44
    v_rcp_f32 v45, v45
    v_cvt_pk_bf16_f32 v46, v24, v25
    v_lshlrev_b32 v24, 16, v46
    v_and_b32 v25, 0xffff0000, v46
    v_cvt_pk_bf16_f32 v46, v26, v27
    v_lshlrev_b32 v26, 16, v46
    v_and_b32 v27, 0xffff0000, v46
    v_cvt_pk_bf16_f32 v46, v28, v29
    v_lshlrev_b32 v28, 16, v46
    v_and_b32 v29, 0xffff0000, v46
    v_cvt_pk_bf16_f32 v46, v30, v31
    v_lshlrev_b32 v30, 16, v46
    v_and_b32 v31, 0xffff0000, v46
    v_mul_f32 v24, v24, v44
    v_mul_f32 v25, v25, v44
    v_mul_f32 v26, v26, v44
    v_mul_f32 v27, v27, v44
    v_mul_f32 v28, v28, v44
    v_mul_f32 v29, v29, v44
    v_mul_f32 v30, v30, v44
    v_mul_f32 v31, v31, v44
    v_cvt_pk_bf16_f32 v16, v24, v25
    v_cvt_pk_bf16_f32 v17, v26, v27
    v_cvt_pk_bf16_f32 v18, v28, v29
    v_cvt_pk_bf16_f32 v19, v30, v31
    v_cvt_pk_bf16_f32 v46, v32, v33
    v_lshlrev_b32 v32, 16, v46
    v_and_b32 v33, 0xffff0000, v46
    v_cvt_pk_bf16_f32 v46, v34, v35
    v_lshlrev_b32 v34, 16, v46
    v_and_b32 v35, 0xffff0000, v46
    v_cvt_pk_bf16_f32 v46, v36, v37
    v_lshlrev_b32 v36, 16, v46
    v_and_b32 v37, 0xffff0000, v46
    v_cvt_pk_bf16_f32 v46, v38, v39
    v_lshlrev_b32 v38, 16, v46
    v_and_b32 v39, 0xffff0000, v46
    v_mul_f32 v32, v32, v45
    v_mul_f32 v33, v33, v45
    v_mul_f32 v34, v34, v45
    v_mul_f32 v35, v35, v45
    v_mul_f32 v36, v36, v45
    v_mul_f32 v37, v37, v45
    v_mul_f32 v38, v38, v45
    v_mul_f32 v39, v39, v45
    v_cvt_pk_bf16_f32 v20, v32, v33
    v_cvt_pk_bf16_f32 v21, v34, v35
    v_cvt_pk_bf16_f32 v22, v36, v37
    v_cvt_pk_bf16_f32 v23, v38, v39
    v_add_u32 v5, 159744, v3
    s_mov_b32 exec_hi, 0x00ffffff
    ds_write_b128 v5, v[16:19]
    ds_write_b128 v5, v[20:23] offset:896
    s_mov_b32 exec_hi, -1
    v_and_b32 v8, 1, v1
    v_mul_u32_u24 v24, 896, v8
    s_add_u32 s34, s40, 159744
    v_add_u32 v24, s34, v24
    v_bfe_u32 v9, v1, 1, 1
    v_bfe_u32 v6, v1, 2, 2
    v_and_b32 v10, 3, v1
    s_cmp_eq_u32 s3, 4
    s_cbranch_scc1 L_h0b
    v_and_b32 v28, 1, v4
    v_lshl_add_u32 v24, v28, 3, v24
    v_lshrrev_b32 v28, 1, v4
    v_cmp_eq_u32 vcc, v28, v9
    v_mov_b32 v27, 162560
    v_mov_b32 v28, v3
    v_cndmask_b32 v24, v27, v24, vcc
    s_lshl_b32 s43, s30, 13
    s_add_u32 s43, s43, 139264
    s_lshl_b32 s42, s31, 10
    s_add_u32 s42, s42, s43
    s_cmp_lg_u32 s28, 5
    s_cselect_b32 s63, -1, 0
    ds_read_b64 v[48:49], v24 offset:0
    ds_read_b64 v[50:51], v24 offset:16
    ds_read_b64 v[52:53], v24 offset:32
    ds_read_b64 v[54:55], v24 offset:48
    ds_read_b64 v[56:57], v24 offset:64
    ds_read_b64 v[58:59], v24 offset:80
    ds_read_b64 v[60:61], v24 offset:96
    s_branch L_h0c
L_h0b:
    v_lshl_add_u32 v24, v4, 3, v24
    ds_read_b64 v[48:49], v24 offset:0
    ds_read_b64 v[50:51], v24 offset:32
    ds_read_b64 v[52:53], v24 offset:64
    ds_read_b64 v[54:55], v24 offset:96
    ds_read_b64 v[56:57], v24 offset:128
    ds_read_b64 v[58:59], v24 offset:160
    ds_read_b64 v[60:61], v24 offset:192
    v_lshlrev_b32 v28, 13, v8
    v_lshl_add_u32 v28, v6, 6, v28
    v_lshl_add_u32 v28, v4, 4, v28
    s_lshl_b32 s42, s28, 14
    s_lshr_b32 s34, s29, 3
    s_lshl_b32 s34, s34, 11
    s_add_u32 s42, s42, s34
    s_and_b32 s34, s29, 7
    s_lshl_b32 s34, s34, 8
    s_add_u32 s42, s42, s34
    s_add_u32 s42, s42, 8192
    s_mov_b32 s63, 0x33333333
    s_lshl_b32 s43, s28, 9
    s_add_u32 s43, s43, 1024
L_h0c:
    s_and_b32 s30, s29, 1
    v_lshl_add_u32 v7, v4, 2, v6
    v_lshlrev_b32 v30, 7, v7
    v_bfe_u32 v7, v7, 1, 2
    v_lshl_add_u32 v30, v7, 5, v30
    v_lshl_add_u32 v30, v10, 3, v30
    v_add_u32 v30, s41, v30
    v_xor_b32 v31, 32, v30
    v_xor_b32 v32, 64, v30
    v_xor_b32 v33, 0x60, v30
    v_mov_b32 v62, 0
    v_mov_b32 v63, 0
    v_mov_b32 v78, 0
    v_mov_b32 v79, 0
    v_mov_b32 v94, 0
    v_mov_b32 v95, 0
    v_mov_b32 v110, 0
    v_mov_b32 v111, 0
    v_mov_b32 v126, 0
    v_mov_b32 v127, 0
    s_waitcnt vmcnt(0) lgkmcnt(0)
    s_add_u32 s60, s60, 1
    s_and_b32 s60, s60, 1023
    v_mov_b32 v15, s60
    ds_read_b64_tr_b16 v[64:65], v30 offset:0
    ds_read_b64_tr_b16 v[66:67], v30 offset:2048
    ds_read_b64_tr_b16 v[68:69], v30 offset:4096
    ds_read_b64_tr_b16 v[70:71], v30 offset:6144
    ds_read_b64_tr_b16 v[72:73], v30 offset:8192
    ds_read_b64_tr_b16 v[74:75], v30 offset:10240
    ds_read_b64_tr_b16 v[76:77], v30 offset:12288
    ds_read_b64_tr_b16 v[80:81], v31 offset:0
    ds_read_b64_tr_b16 v[82:83], v31 offset:2048
    ds_read_b64_tr_b16 v[84:85], v31 offset:4096
    ds_read_b64_tr_b16 v[86:87], v31 offset:6144
    ds_read_b64_tr_b16 v[88:89], v31 offset:8192
    ds_read_b64_tr_b16 v[90:91], v31 offset:10240
    ds_read_b64_tr_b16 v[92:93], v31 offset:12288
    ds_read_b64_tr_b16 v[96:97], v32 offset:0
    ds_read_b64_tr_b16 v[98:99], v32 offset:2048
    ds_read_b64_tr_b16 v[100:101], v32 offset:4096
    ds_read_b64_tr_b16 v[102:103], v32 offset:6144
    ds_read_b64_tr_b16 v[104:105], v32 offset:8192
    ds_read_b64_tr_b16 v[106:107], v32 offset:10240
    ds_read_b64_tr_b16 v[108:109], v32 offset:12288
    ds_read_b64_tr_b16 v[112:113], v33 offset:0
    ds_read_b64_tr_b16 v[114:115], v33 offset:2048
    ds_read_b64_tr_b16 v[116:117], v33 offset:4096
    ds_read_b64_tr_b16 v[118:119], v33 offset:6144
    ds_read_b64_tr_b16 v[120:121], v33 offset:8192
    ds_read_b64_tr_b16 v[122:123], v33 offset:10240
    ds_read_b64_tr_b16 v[124:125], v33 offset:12288
    s_waitcnt lgkmcnt(14)
    v_mfma_f32_16x16x32_bf16 v[128:131], v[64:67], v[48:51], 0
    v_mfma_f32_16x16x32_bf16 v[128:131], v[68:71], v[52:55], v[128:131]
    v_mfma_f32_16x16x32_bf16 v[128:131], v[72:75], v[56:59], v[128:131]
    v_mfma_f32_16x16x32_bf16 v[128:131], v[76:79], v[60:63], v[128:131]
    s_waitcnt lgkmcnt(14)
    v_mfma_f32_16x16x32_bf16 v[132:135], v[80:83], v[48:51], 0
    v_mfma_f32_16x16x32_bf16 v[132:135], v[84:87], v[52:55], v[132:135]
    v_mfma_f32_16x16x32_bf16 v[132:135], v[88:91], v[56:59], v[132:135]
    v_mfma_f32_16x16x32_bf16 v[132:135], v[92:95], v[60:63], v[132:135]
    s_waitcnt lgkmcnt(7)
    v_mfma_f32_16x16x32_bf16 v[136:139], v[96:99], v[48:51], 0
    v_mfma_f32_16x16x32_bf16 v[136:139], v[100:103], v[52:55], v[136:139]
    v_mfma_f32_16x16x32_bf16 v[136:139], v[104:107], v[56:59], v[136:139]
    v_mfma_f32_16x16x32_bf16 v[136:139], v[108:111], v[60:63], v[136:139]
    s_waitcnt lgkmcnt(0)
    v_mfma_f32_16x16x32_bf16 v[140:143], v[112:115], v[48:51], 0
    v_mfma_f32_16x16x32_bf16 v[140:143], v[116:119], v[52:55], v[140:143]
    v_mfma_f32_16x16x32_bf16 v[140:143], v[120:123], v[56:59], v[140:143]
    v_mfma_f32_16x16x32_bf16 v[140:143], v[124:127], v[60:63], v[140:143]
    s_getreg_b32 s59, hwreg(HW_REG_XCC_ID, 0, 4)
    s_lshl_b32 s59, s59, 16
    v_mov_b32_dpp v128, v132 quad_perm:[0,1,2,3] row_mask:0xf bank_mask:0x2
    v_mov_b32_dpp v129, v133 quad_perm:[0,1,2,3] row_mask:0xf bank_mask:0x2
    v_mov_b32_dpp v130, v134 quad_perm:[0,1,2,3] row_mask:0xf bank_mask:0x2
    v_mov_b32_dpp v131, v135 quad_perm:[0,1,2,3] row_mask:0xf bank_mask:0x2
    v_mov_b32_dpp v128, v136 quad_perm:[0,1,2,3] row_mask:0xf bank_mask:0x4
    v_mov_b32_dpp v129, v137 quad_perm:[0,1,2,3] row_mask:0xf bank_mask:0x4
    v_mov_b32_dpp v130, v138 quad_perm:[0,1,2,3] row_mask:0xf bank_mask:0x4
    v_mov_b32_dpp v131, v139 quad_perm:[0,1,2,3] row_mask:0xf bank_mask:0x4
    v_mov_b32_dpp v128, v140 quad_perm:[0,1,2,3] row_mask:0xf bank_mask:0x8
    v_mov_b32_dpp v129, v141 quad_perm:[0,1,2,3] row_mask:0xf bank_mask:0x8
    v_mov_b32_dpp v130, v142 quad_perm:[0,1,2,3] row_mask:0xf bank_mask:0x8
    v_mov_b32_dpp v131, v143 quad_perm:[0,1,2,3] row_mask:0xf bank_mask:0x8
    v_bfi_b32 v128, s62, v15, v128
    v_bfi_b32 v129, s62, v15, v129
    v_bfi_b32 v130, s62, v15, v130
    v_bfi_b32 v131, s62, v15, v131
    s_mov_b32 exec_lo, s63
    s_mov_b32 exec_hi, s63

    buffer_store_dwordx4 v[128:131], v28, s[44:47], s42 offen
L_nopub:
    s_mov_b64 exec, -1
    s_sub_u32 s32, s3, 4
    v_and_b32 v8, 1, v1
    s_sub_u32 s35, s41, 131072
    s_lshl_b32 s34, s32, 13
    s_sub_u32 s35, s34, s35
    v_add_u32 v40, s35, v30
    v_add_u32 v41, s35, v31
    v_add_u32 v42, s35, v32
    v_add_u32 v43, s35, v33
    v_bfe_u32 v6, v1, 1, 3
    s_lshr_b32 s34, s29, 3
    s_lshl_b32 s56, s28, 2
    s_add_u32 s56, s56, s34
    s_lshl_b32 s56, s56, 1
    s_add_u32 s35, s56, s32
    s_lshl_b32 s56, s35, 13
    s_add_u32 s56, s56, 401408
    s_add_u32 s57, s56, 4096
    v_bfe_u32 v7, v1, 2, 2
    v_lshlrev_b32 v13, 12, v7
    v_lshl_add_u32 v13, v8, 14, v13
    v_lshl_add_u32 v13, v4, 4, v13
    s_lshl_b32 s58, s35, 6
    s_and_b32 s35, s29, 7
    s_lshl_b32 s35, s35, 15
    s_add_u32 s58, s58, s35
    s_add_u32 s58, s58, 925696
    v_lshlrev_b32 v14, 7, v8
    v_lshl_add_u32 v14, v4, 4, v14
    s_lshl_b32 s35, s32, 6
    s_add_u32 s35, s35, 159744
    v_add_u32 v14, s35, v14
    v_mov_b32 v7, 162560
    v_cmp_eq_u32 vcc, 0, v6
    s_nop 1
    v_cndmask_b32 v14, v7, v14, vcc
    s_barrier
    s_cmp_eq_u32 s3, 4
    s_cbranch_scc0 L_h1g
    s_lshl_b32 s34, s28, 14
    s_lshl_b32 s35, s30, 13
    s_add_u32 s34, s34, s35
    s_add_u32 s34, s34, 8192
    s_add_u32 s35, s34, 4096
    v_and_b32 v5, 0x1ff, v3
    s_movk_i32 s33, 5000
    s_branch L_id1
L_id0:
    s_sleep 4
L_id1:
    buffer_load_dwordx4 v[96:99], v5, s[44:47], s43 offen sc1
    buffer_load_dwordx4 v[64:67], v3, s[44:47], s34 offen offset:0 sc1
    buffer_load_dwordx4 v[68:71], v3, s[44:47], s34 offen offset:1024 sc1
    buffer_load_dwordx4 v[72:75], v3, s[44:47], s34 offen offset:2048 sc1
    buffer_load_dwordx4 v[76:79], v3, s[44:47], s34 offen offset:3072 sc1
    buffer_load_dwordx4 v[80:83], v3, s[44:47], s35 offen offset:0 sc1
    buffer_load_dwordx4 v[84:87], v3, s[44:47], s35 offen offset:1024 sc1
    buffer_load_dwordx4 v[88:91], v3, s[44:47], s35 offen offset:2048 sc1
    buffer_load_dwordx4 v[92:95], v3, s[44:47], s35 offen offset:3072 sc1
    s_sub_u32 s33, s33, 1
    s_cbranch_scc1 L_idd
    s_waitcnt vmcnt(8)
    v_xor_b32 v96, v15, v96
    v_xor_b32 v97, v15, v97
    v_xor_b32 v98, v15, v98
    v_xor_b32 v99, v15, v99
    v_or3_b32 v7, v96, v97, v98
    v_or_b32 v7, v7, v99
    v_and_b32 v7, s62, v7
    v_cmp_ne_u32 vcc, 0, v7
    s_cbranch_vccz L_idd
    s_waitcnt vmcnt(0)
    s_branch L_id0
L_idd:
    v_cmp_ne_u32 vcc, s59, v96
    s_cmp_eq_u64 vcc, 0
    s_cselect_b32 s61, 1, 0
    s_cbranch_scc1 L_q2
    s_mov_b32 exec_lo, s63
    s_mov_b32 exec_hi, s63
    buffer_store_dwordx4 v[128:131], v28, s[44:47], s42 offen sc1
    s_mov_b64 exec, -1
    s_branch L_q2
L_q0:
    s_sleep 4
L_q1:
    buffer_load_dwordx4 v[64:67], v3, s[44:47], s34 offen offset:0 sc1
    buffer_load_dwordx4 v[68:71], v3, s[44:47], s34 offen offset:1024 sc1
    buffer_load_dwordx4 v[72:75], v3, s[44:47], s34 offen offset:2048 sc1
    buffer_load_dwordx4 v[76:79], v3, s[44:47], s34 offen offset:3072 sc1
    buffer_load_dwordx4 v[80:83], v3, s[44:47], s35 offen offset:0 sc1
    buffer_load_dwordx4 v[84:87], v3, s[44:47], s35 offen offset:1024 sc1
    buffer_load_dwordx4 v[88:91], v3, s[44:47], s35 offen offset:2048 sc1
    buffer_load_dwordx4 v[92:95], v3, s[44:47], s35 offen offset:3072 sc1
L_q2:
    s_sub_u32 s33, s33, 1
    s_cbranch_scc1 L_qd
    s_waitcnt vmcnt(0)
    v_xor_b32 v64, v15, v64
    v_xor_b32 v65, v15, v65
    v_xor_b32 v66, v15, v66
    v_xor_b32 v67, v15, v67
    v_xor_b32 v68, v15, v68
    v_xor_b32 v69, v15, v69
    v_xor_b32 v70, v15, v70
    v_xor_b32 v71, v15, v71
    v_xor_b32 v72, v15, v72
    v_xor_b32 v73, v15, v73
    v_xor_b32 v74, v15, v74
    v_xor_b32 v75, v15, v75
    v_xor_b32 v76, v15, v76
    v_xor_b32 v77, v15, v77
    v_xor_b32 v78, v15, v78
    v_xor_b32 v79, v15, v79
    v_xor_b32 v80, v15, v80
    v_xor_b32 v81, v15, v81
    v_xor_b32 v82, v15, v82
    v_xor_b32 v83, v15, v83
    v_xor_b32 v84, v15, v84
    v_xor_b32 v85, v15, v85
    v_xor_b32 v86, v15, v86
    v_xor_b32 v87, v15, v87
    v_xor_b32 v88, v15, v88
    v_xor_b32 v89, v15, v89
    v_xor_b32 v90, v15, v90
    v_xor_b32 v91, v15, v91
    v_xor_b32 v92, v15, v92
    v_xor_b32 v93, v15, v93
    v_xor_b32 v94, v15, v94
    v_xor_b32 v95, v15, v95
    v_or3_b32 v7, v64, v65, v66
    v_or3_b32 v7, v7, v67, v68
    v_or3_b32 v7, v7, v69, v70
    v_or3_b32 v7, v7, v71, v72
    v_or3_b32 v7, v7, v73, v74
    v_or3_b32 v7, v7, v75, v76
    v_or3_b32 v7, v7, v77, v78
    v_or3_b32 v7, v7, v79, v80
    v_or3_b32 v7, v7, v81, v82
    v_or3_b32 v7, v7, v83, v84
    v_or3_b32 v7, v7, v85, v86
    v_or3_b32 v7, v7, v87, v88
    v_or3_b32 v7, v7, v89, v90
    v_or3_b32 v7, v7, v91, v92
    v_or3_b32 v7, v7, v93, v94
    v_or_b32 v7, v7, v95
    v_and_b32 v7, s62, v7
    v_cmp_ne_u32 vcc, 0, v7
    s_cbranch_vccnz L_q0
L_qd:
    s_waitcnt vmcnt(0)
    v_pk_add_f32 v[64:65], v[64:65], v[72:73]
    v_pk_add_f32 v[80:81], v[80:81], v[88:89]
    v_pk_add_f32 v[66:67], v[66:67], v[74:75]
    v_pk_add_f32 v[82:83], v[82:83], v[90:91]
    v_pk_add_f32 v[68:69], v[68:69], v[76:77]
    v_pk_add_f32 v[84:85], v[84:85], v[92:93]
    v_pk_add_f32 v[70:71], v[70:71], v[78:79]
    v_pk_add_f32 v[86:87], v[86:87], v[94:95]
    v_pk_add_f32 v[64:65], v[64:65], v[80:81]
    v_pk_add_f32 v[66:67], v[66:67], v[82:83]
    v_pk_add_f32 v[68:69], v[68:69], v[84:85]
    v_pk_add_f32 v[70:71], v[70:71], v[86:87]
    v_lshlrev_b32 v5, 3, v1
    v_add_u32 v5, 161536, v5
    v_cvt_pk_bf16_f32 v16, v64, v65
    v_cvt_pk_bf16_f32 v17, v66, v67
    v_cvt_pk_bf16_f32 v18, v68, v69
    v_cvt_pk_bf16_f32 v19, v70, v71
    v_mov_b32 v20, 1
    v_mov_b32 v21, s61
    v_mov_b32 v7, 162720
    ds_write_b64 v5, v[16:17]
    ds_write_b64 v5, v[18:19] offset:512
    ds_write_b64 v7, v[20:21]
    s_branch L_h1s
L_h1g:
    s_cmp_eq_u32 s28, 5
    s_cbranch_scc1 L_h1s
    v_mov_b32 v7, 162720
    s_movk_i32 s33, 20000
    s_mov_b64 exec, 1
L_hq:
    s_sleep 8
    ds_read_b64 v[16:17], v7
    s_sub_u32 s33, s33, 1
    s_cbranch_scc1 L_hqd
    s_waitcnt lgkmcnt(0)
    v_cmp_eq_u32 vcc, 0, v16
    s_cbranch_vccnz L_hq
L_hqd:
    s_waitcnt lgkmcnt(0)
    v_cmp_eq_u32 vcc, 0, v17
    s_mov_b64 exec, -1
    s_cbranch_vccz L_hqp
    buffer_store_dwordx4 v[128:131], v28, s[44:47], s42 offen sc1
L_hqp:
    s_and_b32 s34, s29, 7
    s_cmp_eq_u32 s34, 7
    s_cbranch_scc1 L_idle
    s_add_u32 s35, s43, 4096
    s_movk_i32 s33, 5000
    s_branch L_g1
L_g0:
    s_sleep 4
L_g1:
    buffer_load_dwordx4 v[64:67], v3, s[44:47], s43 offen offset:0 sc1
    buffer_load_dwordx4 v[68:71], v3, s[44:47], s43 offen offset:1024 sc1
    buffer_load_dwordx4 v[72:75], v3, s[44:47], s43 offen offset:2048 sc1
    buffer_load_dwordx4 v[76:79], v3, s[44:47], s43 offen offset:3072 sc1
    buffer_load_dwordx4 v[80:83], v3, s[44:47], s35 offen offset:0 sc1
    buffer_load_dwordx4 v[84:87], v3, s[44:47], s35 offen offset:1024 sc1
    buffer_load_dwordx4 v[88:91], v3, s[44:47], s35 offen offset:2048 sc1
    buffer_load_dwordx4 v[92:95], v3, s[44:47], s35 offen offset:3072 sc1
    s_sub_u32 s33, s33, 1
    s_cbranch_scc1 L_gd
    s_waitcnt vmcnt(0)
    v_xor_b32 v64, v15, v64
    v_xor_b32 v65, v15, v65
    v_xor_b32 v66, v15, v66
    v_xor_b32 v67, v15, v67
    v_xor_b32 v68, v15, v68
    v_xor_b32 v69, v15, v69
    v_xor_b32 v70, v15, v70
    v_xor_b32 v71, v15, v71
    v_xor_b32 v72, v15, v72
    v_xor_b32 v73, v15, v73
    v_xor_b32 v74, v15, v74
    v_xor_b32 v75, v15, v75
    v_xor_b32 v76, v15, v76
    v_xor_b32 v77, v15, v77
    v_xor_b32 v78, v15, v78
    v_xor_b32 v79, v15, v79
    v_xor_b32 v80, v15, v80
    v_xor_b32 v81, v15, v81
    v_xor_b32 v82, v15, v82
    v_xor_b32 v83, v15, v83
    v_xor_b32 v84, v15, v84
    v_xor_b32 v85, v15, v85
    v_xor_b32 v86, v15, v86
    v_xor_b32 v87, v15, v87
    v_xor_b32 v88, v15, v88
    v_xor_b32 v89, v15, v89
    v_xor_b32 v90, v15, v90
    v_xor_b32 v91, v15, v91
    v_xor_b32 v92, v15, v92
    v_xor_b32 v93, v15, v93
    v_xor_b32 v94, v15, v94
    v_xor_b32 v95, v15, v95
    v_or3_b32 v7, v64, v65, v66
    v_or3_b32 v7, v7, v67, v68
    v_or3_b32 v7, v7, v69, v70
    v_or3_b32 v7, v7, v71, v72
    v_or3_b32 v7, v7, v73, v74
    v_or3_b32 v7, v7, v75, v76
    v_or3_b32 v7, v7, v77, v78
    v_or3_b32 v7, v7, v79, v80
    v_or3_b32 v7, v7, v81, v82
    v_or3_b32 v7, v7, v83, v84
    v_or3_b32 v7, v7, v85, v86
    v_or3_b32 v7, v7, v87, v88
    v_or3_b32 v7, v7, v89, v90
    v_or3_b32 v7, v7, v91, v92
    v_or3_b32 v7, v7, v93, v94
    v_or_b32 v7, v7, v95
    v_and_b32 v7, s62, v7
    v_cmp_ne_u32 vcc, 0, v7
    s_cbranch_vccnz L_g0
L_gd:
    s_waitcnt vmcnt(0)
    v_pk_add_f32 v[64:65], v[64:65], v[80:81]
    v_pk_add_f32 v[66:67], v[66:67], v[82:83]
    v_pk_add_f32 v[68:69], v[68:69], v[84:85]
    v_pk_add_f32 v[70:71], v[70:71], v[86:87]
    v_pk_add_f32 v[72:73], v[72:73], v[88:89]
    v_pk_add_f32 v[74:75], v[74:75], v[90:91]
    v_pk_add_f32 v[76:77], v[76:77], v[92:93]
    v_pk_add_f32 v[78:79], v[78:79], v[94:95]
    v_pk_add_f32 v[64:65], v[64:65], v[72:73]
    v_pk_add_f32 v[66:67], v[66:67], v[74:75]
    v_pk_add_f32 v[68:69], v[68:69], v[76:77]
    v_pk_add_f32 v[70:71], v[70:71], v[78:79]
    v_pk_add_f32 v[16:17], v[64:65], v[68:69]
    v_pk_add_f32 v[18:19], v[66:67], v[70:71]
    v_cvt_pk_bf16_f32 v16, v16, v17
    v_and_b32 v17, 0xffff0000, v16
    v_lshlrev_b32 v16, 16, v16
    v_cvt_pk_bf16_f32 v18, v18, v19
    v_and_b32 v19, 0xffff0000, v18
    v_lshlrev_b32 v18, 16, v18
    v_max_f32 v20, 0, v16
    v_max_f32 v21, 0, v17
    v_max_f32 v22, 0, v18
    v_max_f32 v23, 0, v19
    v_mul_f32_dpp v20, v16, v20 quad_perm:[2,3,0,1] row_mask:0xf bank_mask:0xf
    v_mul_f32_dpp v21, v17, v21 quad_perm:[2,3,0,1] row_mask:0xf bank_mask:0xf
    v_mul_f32_dpp v22, v18, v22 quad_perm:[2,3,0,1] row_mask:0xf bank_mask:0xf
    v_mul_f32_dpp v23, v19, v23 quad_perm:[2,3,0,1] row_mask:0xf bank_mask:0xf
    v_bfe_u32 v5, v1, 3, 1
    v_lshlrev_b32 v5, 6, v5
    v_lshl_add_u32 v5, v8, 7, v5
    v_lshl_add_u32 v5, v4, 4, v5
    v_bfe_u32 v6, v1, 2, 1
    v_lshl_add_u32 v5, v6, 3, v5
    v_add_u32 v5, 159744, v5
    v_cvt_pk_bf16_f32 v16, v20, v21
    v_cvt_pk_bf16_f32 v17, v22, v23
    s_mov_b32 exec_lo, 0x33333333
    s_mov_b32 exec_hi, 0x33333333
    ds_write_b64 v5, v[16:17]
    s_mov_b64 exec, -1
L_h1s:
    s_and_b32 s34, s29, 7
    s_cmp_eq_u32 s34, 7
    s_cbranch_scc1 L_idle
    v_mov_b32 v7, 162720
    s_movk_i32 s33, 20000
    s_mov_b64 exec, 1
L_sw:
    s_sleep 8
    ds_read_b128 v[16:19], v7 offset:16
    s_sub_u32 s33, s33, 1
    s_cbranch_scc1 L_swd
    s_waitcnt lgkmcnt(0)
    v_and_b32 v16, v16, v17
    v_and_b32 v18, v18, v19
    v_and_b32 v16, v16, v18
    v_cmp_eq_u32 vcc, 0, v16
    s_cbranch_vccnz L_sw
L_swd:
    s_mov_b64 exec, -1
    s_lshl_b32 s34, s28, 1
    s_lshr_b32 s35, s29, 4
    s_add_u32 s34, s34, s35
    s_lshl_b32 s34, s34, 11
    s_add_u32 s34, s34, 368640
    s_movk_i32 s33, 5000

L_s0:
    s_sleep 8
    buffer_load_dwordx4 v[16:19], v3, s[44:47], s34 offen sc1
    buffer_load_dwordx4 v[20:23], v3, s[44:47], s34 offen offset:1024 sc1
    s_sub_u32 s33, s33, 1
    s_cbranch_scc1 L_sd
    s_waitcnt vmcnt(0)
    v_xor_b32 v16, v15, v16
    v_xor_b32 v17, v15, v17
    v_xor_b32 v18, v15, v18
    v_xor_b32 v19, v15, v19
    v_xor_b32 v20, v15, v20
    v_xor_b32 v21, v15, v21
    v_xor_b32 v22, v15, v22
    v_xor_b32 v23, v15, v23
    v_or3_b32 v7, v16, v17, v18
    v_or3_b32 v7, v7, v19, v20
    v_or3_b32 v7, v7, v21, v22
    v_or_b32 v7, v7, v23
    v_and_b32 v7, s62, v7
    v_cmp_ne_u32 vcc, 0, v7
    s_cbranch_vccnz L_s0
L_sd:
    s_waitcnt vmcnt(0)
    v_max_f32 v24, v16, v20
    s_nop 1
    v_max_f32_dpp v24, v24, v24 quad_perm:[2,3,0,1] row_mask:0xf bank_mask:0xf
    s_nop 1
    v_max_f32_dpp v24, v24, v24 row_ror:4 row_mask:0xf bank_mask:0xf
    s_nop 1
    v_max_f32_dpp v24, v24, v24 row_ror:8 row_mask:0xf bank_mask:0xf
    v_sub_f32 v16, v16, v24
    v_sub_f32 v20, v20, v24
    v_exp_f32 v16, v16
    v_exp_f32 v20, v20
    s_nop 0
    v_mul_f32 v24, v16, v17
    v_fmac_f32 v24, v20, v21
    s_nop 1
    v_add_f32_dpp v24, v24, v24 quad_perm:[2,3,0,1] row_mask:0xf bank_mask:0xf
    s_nop 1
    v_add_f32_dpp v24, v24, v24 row_ror:4 row_mask:0xf bank_mask:0xf
    s_nop 1
    v_add_f32_dpp v24, v24, v24 row_ror:8 row_mask:0xf bank_mask:0xf
    v_mov_b32 v25, v24
    s_nop 1
    v_permlane16_swap_b32 v25, v24
    v_add_f32 v24, v24, v25
    v_mov_b32 v25, v24
    s_nop 1
    v_permlane32_swap_b32 v25, v24
    v_add_f32 v24, v24, v25
    v_rcp_f32 v24, v24
    s_nop 0
    v_mul_f32 v18, v16, v24
    v_mul_f32 v19, v20, v24
    s_movk_i32 s33, 20000
    v_mov_b32 v7, 162720
    s_mov_b64 exec, 1
L_ow:
    s_sleep 1
    ds_read_b32 v16, v7 offset:40
    s_sub_u32 s33, s33, 1
    s_cbranch_scc1 L_owd
    s_waitcnt lgkmcnt(0)
    v_cmp_gt_u32 vcc, 4, v16
    s_cbranch_vccnz L_ow
L_owd:
    s_mov_b64 exec, -1
    buffer_load_dwordx4 v[112:115], v3, s[44:47], s56 offen offset:0 sc1
    buffer_load_dwordx4 v[128:131], v3, s[44:47], s56 offen offset:1024 sc1
    buffer_load_dwordx4 v[116:119], v3, s[44:47], s56 offen offset:2048 sc1
    buffer_load_dwordx4 v[132:135], v3, s[44:47], s56 offen offset:3072 sc1
    buffer_load_dwordx4 v[120:123], v3, s[44:47], s57 offen offset:0 sc1
    buffer_load_dwordx4 v[136:139], v3, s[44:47], s57 offen offset:1024 sc1
    buffer_load_dwordx4 v[124:127], v3, s[44:47], s57 offen offset:2048 sc1
    buffer_load_dwordx4 v[140:143], v3, s[44:47], s57 offen offset:3072 sc1
    s_waitcnt lgkmcnt(0)
    s_barrier
    s_lshl_b32 s35, s32, 12
    s_sub_u32 s35, 16384, s35
    ds_read_b128 v[60:63], v14
    v_add_u32 v44, s35, v40
    v_add_u32 v45, s35, v41
    v_add_u32 v46, s35, v42
    v_add_u32 v47, s35, v43
    ds_read_b64_tr_b16 v[96:97], v44 offset:0
    ds_read_b64_tr_b16 v[98:99], v44 offset:2048
    ds_read_b64_tr_b16 v[100:101], v45 offset:0
    ds_read_b64_tr_b16 v[102:103], v45 offset:2048
    ds_read_b64_tr_b16 v[104:105], v46 offset:0
    ds_read_b64_tr_b16 v[106:107], v46 offset:2048
    ds_read_b64_tr_b16 v[108:109], v47 offset:0
    ds_read_b64_tr_b16 v[110:111], v47 offset:2048
    ds_read_b64_tr_b16 v[64:65], v40 offset:0
    ds_read_b64_tr_b16 v[66:67], v40 offset:2048
    ds_read_b64_tr_b16 v[72:73], v42 offset:0
    ds_read_b64_tr_b16 v[74:75], v42 offset:2048
    ds_read_b64_tr_b16 v[68:69], v41 offset:0
    ds_read_b64_tr_b16 v[70:71], v41 offset:2048
    ds_read_b64_tr_b16 v[76:77], v43 offset:0
    ds_read_b64_tr_b16 v[78:79], v43 offset:2048
    ds_read_b64_tr_b16 v[80:81], v40 offset:4096
    ds_read_b64_tr_b16 v[82:83], v40 offset:6144
    ds_read_b64_tr_b16 v[88:89], v42 offset:4096
    ds_read_b64_tr_b16 v[90:91], v42 offset:6144
    ds_read_b64_tr_b16 v[84:85], v41 offset:4096
    ds_read_b64_tr_b16 v[86:87], v41 offset:6144
    ds_read_b64_tr_b16 v[92:93], v43 offset:4096
    ds_read_b64_tr_b16 v[94:95], v43 offset:6144
    s_cmp_eq_u32 s28, 5
    s_cbranch_scc1 L_noffn
    s_waitcnt lgkmcnt(15)
    v_mfma_f32_16x16x32_bf16 v[36:39], v[96:99], v[60:63], 0
    v_mfma_f32_16x16x32_bf16 v[40:43], v[100:103], v[60:63], 0
    v_mfma_f32_16x16x32_bf16 v[44:47], v[104:107], v[60:63], 0
    v_mfma_f32_16x16x32_bf16 v[48:51], v[108:111], v[60:63], 0
    s_branch L_ffnd
L_noffn:
    v_mov_b32 v36, 0
    v_mov_b32 v37, 0
    v_mov_b32 v38, 0
    v_mov_b32 v39, 0
    v_mov_b32 v40, 0
    v_mov_b32 v41, 0
    v_mov_b32 v42, 0
    v_mov_b32 v43, 0
    v_mov_b32 v44, 0
    v_mov_b32 v45, 0
    v_mov_b32 v46, 0
    v_mov_b32 v47, 0
    v_mov_b32 v48, 0
    v_mov_b32 v49, 0
    v_mov_b32 v50, 0
    v_mov_b32 v51, 0
L_ffnd:
    s_movk_i32 s33, 5000
    s_branch L_opoll_e
L_opoll:
    s_sleep 1
    buffer_load_dwordx4 v[112:115], v3, s[44:47], s56 offen offset:0 sc1
    buffer_load_dwordx4 v[128:131], v3, s[44:47], s56 offen offset:1024 sc1
    buffer_load_dwordx4 v[116:119], v3, s[44:47], s56 offen offset:2048 sc1
    buffer_load_dwordx4 v[132:135], v3, s[44:47], s56 offen offset:3072 sc1
    buffer_load_dwordx4 v[120:123], v3, s[44:47], s57 offen offset:0 sc1
    buffer_load_dwordx4 v[136:139], v3, s[44:47], s57 offen offset:1024 sc1
    buffer_load_dwordx4 v[124:127], v3, s[44:47], s57 offen offset:2048 sc1
    buffer_load_dwordx4 v[140:143], v3, s[44:47], s57 offen offset:3072 sc1
L_opoll_e:
    s_waitcnt vmcnt(7)
    v_xor_b32 v112, v15, v112
    v_xor_b32 v113, v15, v113
    v_xor_b32 v114, v15, v114
    v_xor_b32 v115, v15, v115
    v_or3_b32 v5, v112, v113, v114
    v_or_b32 v5, v5, v115
    s_waitcnt vmcnt(6)
    v_xor_b32 v128, v15, v128
    v_xor_b32 v129, v15, v129
    v_xor_b32 v130, v15, v130
    v_xor_b32 v131, v15, v131
    v_or3_b32 v5, v5, v128, v129
    v_or3_b32 v5, v5, v130, v131
    v_pk_mul_f32 v[20:21], v[112:113], v[18:19] op_sel_hi:[1,0]
    v_pk_mul_f32 v[22:23], v[114:115], v[18:19] op_sel_hi:[1,0]
    v_pk_fma_f32 v[20:21], v[128:129], v[18:19], v[20:21] op_sel:[0,1,0] op_sel_hi:[1,1,1]
    v_pk_fma_f32 v[22:23], v[130:131], v[18:19], v[22:23] op_sel:[0,1,0] op_sel_hi:[1,1,1]
    v_cvt_pk_bf16_f32 v52, v20, v21
    v_cvt_pk_bf16_f32 v53, v22, v23
    s_waitcnt vmcnt(5)
    v_xor_b32 v116, v15, v116
    v_xor_b32 v117, v15, v117
    v_xor_b32 v118, v15, v118
    v_xor_b32 v119, v15, v119
    v_or3_b32 v5, v5, v116, v117
    v_or3_b32 v5, v5, v118, v119
    s_waitcnt vmcnt(4)
    v_xor_b32 v132, v15, v132
    v_xor_b32 v133, v15, v133
    v_xor_b32 v134, v15, v134
    v_xor_b32 v135, v15, v135
    v_or3_b32 v5, v5, v132, v133
    v_or3_b32 v5, v5, v134, v135
    v_pk_mul_f32 v[24:25], v[116:117], v[18:19] op_sel_hi:[1,0]
    v_pk_mul_f32 v[26:27], v[118:119], v[18:19] op_sel_hi:[1,0]
    v_pk_fma_f32 v[24:25], v[132:133], v[18:19], v[24:25] op_sel:[0,1,0] op_sel_hi:[1,1,1]
    v_pk_fma_f32 v[26:27], v[134:135], v[18:19], v[26:27] op_sel:[0,1,0] op_sel_hi:[1,1,1]
    v_cvt_pk_bf16_f32 v54, v24, v25
    v_cvt_pk_bf16_f32 v55, v26, v27
    s_waitcnt vmcnt(3)
    v_xor_b32 v120, v15, v120
    v_xor_b32 v121, v15, v121
    v_xor_b32 v122, v15, v122
    v_xor_b32 v123, v15, v123
    v_or3_b32 v5, v5, v120, v121
    v_or3_b32 v5, v5, v122, v123
    s_waitcnt vmcnt(2)
    v_xor_b32 v136, v15, v136
    v_xor_b32 v137, v15, v137
    v_xor_b32 v138, v15, v138
    v_xor_b32 v139, v15, v139
    v_or3_b32 v5, v5, v136, v137
    v_or3_b32 v5, v5, v138, v139
    v_pk_mul_f32 v[28:29], v[120:121], v[18:19] op_sel_hi:[1,0]
    v_pk_mul_f32 v[30:31], v[122:123], v[18:19] op_sel_hi:[1,0]
    v_pk_fma_f32 v[28:29], v[136:137], v[18:19], v[28:29] op_sel:[0,1,0] op_sel_hi:[1,1,1]
    v_pk_fma_f32 v[30:31], v[138:139], v[18:19], v[30:31] op_sel:[0,1,0] op_sel_hi:[1,1,1]
    v_cvt_pk_bf16_f32 v56, v28, v29
    v_cvt_pk_bf16_f32 v57, v30, v31
    s_waitcnt vmcnt(1)
    v_xor_b32 v124, v15, v124
    v_xor_b32 v125, v15, v125
    v_xor_b32 v126, v15, v126
    v_xor_b32 v127, v15, v127
    v_or3_b32 v5, v5, v124, v125
    v_or3_b32 v5, v5, v126, v127
    s_waitcnt vmcnt(0)
    v_xor_b32 v140, v15, v140
    v_xor_b32 v141, v15, v141
    v_xor_b32 v142, v15, v142
    v_xor_b32 v143, v15, v143
    v_or3_b32 v5, v5, v140, v141
    v_or3_b32 v5, v5, v142, v143
    v_pk_mul_f32 v[32:33], v[124:125], v[18:19] op_sel_hi:[1,0]
    v_pk_mul_f32 v[34:35], v[126:127], v[18:19] op_sel_hi:[1,0]
    v_pk_fma_f32 v[32:33], v[140:141], v[18:19], v[32:33] op_sel:[0,1,0] op_sel_hi:[1,1,1]
    v_pk_fma_f32 v[34:35], v[142:143], v[18:19], v[34:35] op_sel:[0,1,0] op_sel_hi:[1,1,1]
    v_cvt_pk_bf16_f32 v58, v32, v33
    v_cvt_pk_bf16_f32 v59, v34, v35
    v_and_b32 v5, s62, v5
    v_cmp_eq_u32 vcc, 0, v5
    s_andn2_b64 s[48:49], exec, vcc
    s_mov_b64 exec, s[48:49]
    s_cbranch_execz L_opoll_d
    s_sub_u32 s33, s33, 1
    s_cbranch_scc0 L_opoll
L_opoll_d:
    s_mov_b64 exec, -1
    s_waitcnt lgkmcnt(0)
    v_mfma_f32_16x16x32_bf16 v[36:39], v[64:67], v[52:55], v[36:39]
    v_mfma_f32_16x16x32_bf16 v[44:47], v[72:75], v[52:55], v[44:47]
    v_mfma_f32_16x16x32_bf16 v[40:43], v[68:71], v[52:55], v[40:43]
    v_mfma_f32_16x16x32_bf16 v[48:51], v[76:79], v[52:55], v[48:51]
    v_mfma_f32_16x16x32_bf16 v[36:39], v[80:83], v[56:59], v[36:39]
    v_mfma_f32_16x16x32_bf16 v[44:47], v[88:91], v[56:59], v[44:47]
    v_mfma_f32_16x16x32_bf16 v[40:43], v[84:87], v[56:59], v[40:43]
    v_mfma_f32_16x16x32_bf16 v[48:51], v[92:95], v[56:59], v[48:51]
    s_nop 4
    v_add_f32_dpp v36, v36, v36 row_ror:8 row_mask:0xf bank_mask:0x3
    v_add_f32_dpp v37, v37, v37 row_ror:8 row_mask:0xf bank_mask:0x3
    v_add_f32_dpp v38, v38, v38 row_ror:8 row_mask:0xf bank_mask:0x3
    v_add_f32_dpp v39, v39, v39 row_ror:8 row_mask:0xf bank_mask:0x3
    v_add_f32_dpp v36, v44, v44 row_ror:8 row_mask:0xf bank_mask:0xc
    v_add_f32_dpp v37, v45, v45 row_ror:8 row_mask:0xf bank_mask:0xc
    v_add_f32_dpp v38, v46, v46 row_ror:8 row_mask:0xf bank_mask:0xc
    v_add_f32_dpp v39, v47, v47 row_ror:8 row_mask:0xf bank_mask:0xc
    v_add_f32_dpp v40, v40, v40 row_ror:8 row_mask:0xf bank_mask:0x3
    v_add_f32_dpp v41, v41, v41 row_ror:8 row_mask:0xf bank_mask:0x3
    v_add_f32_dpp v42, v42, v42 row_ror:8 row_mask:0xf bank_mask:0x3
    v_add_f32_dpp v43, v43, v43 row_ror:8 row_mask:0xf bank_mask:0x3
    v_add_f32_dpp v40, v48, v48 row_ror:8 row_mask:0xf bank_mask:0xc
    v_add_f32_dpp v41, v49, v49 row_ror:8 row_mask:0xf bank_mask:0xc
    v_add_f32_dpp v42, v50, v50 row_ror:8 row_mask:0xf bank_mask:0xc
    v_add_f32_dpp v43, v51, v51 row_ror:8 row_mask:0xf bank_mask:0xc
    v_add_f32_dpp v36, v36, v36 row_ror:12 row_mask:0xf bank_mask:0x5
    v_add_f32_dpp v37, v37, v37 row_ror:12 row_mask:0xf bank_mask:0x5
    v_add_f32_dpp v38, v38, v38 row_ror:12 row_mask:0xf bank_mask:0x5
    v_add_f32_dpp v39, v39, v39 row_ror:12 row_mask:0xf bank_mask:0x5
    v_add_f32_dpp v36, v40, v40 row_ror:4 row_mask:0xf bank_mask:0xa
    v_add_f32_dpp v37, v41, v41 row_ror:4 row_mask:0xf bank_mask:0xa
    v_add_f32_dpp v38, v42, v42 row_ror:4 row_mask:0xf bank_mask:0xa
    v_add_f32_dpp v39, v43, v43 row_ror:4 row_mask:0xf bank_mask:0xa
    v_add_f32_dpp v36, v36, v36 quad_perm:[2,3,0,1] row_mask:0xf bank_mask:0xf
    v_add_f32_dpp v37, v37, v37 quad_perm:[2,3,0,1] row_mask:0xf bank_mask:0xf
    v_add_f32_dpp v38, v38, v38 quad_perm:[2,3,0,1] row_mask:0xf bank_mask:0xf
    v_add_f32_dpp v39, v39, v39 quad_perm:[2,3,0,1] row_mask:0xf bank_mask:0xf
    v_bfi_b32 v36, s62, v15, v36
    v_bfi_b32 v37, s62, v15, v37
    v_bfi_b32 v38, s62, v15, v38
    v_bfi_b32 v39, s62, v15, v39
    s_mov_b32 exec_lo, 0x33333333
    s_mov_b32 exec_hi, 0x33333333
    buffer_store_dwordx4 v[36:39], v13, s[44:47], s58 offen sc1
    s_mov_b64 exec, -1
    s_barrier
    s_branch L_fin
L_idle:
    s_waitcnt lgkmcnt(0)
    s_barrier
    s_branch L_fin
.p2align 8
L_nh:
    s_load_dwordx8 s[20:27], s[0:1], 64
    s_and_b32 s30, s29, 1
    s_lshr_b32 s31, s2, 4
    v_lshrrev_b32 v4, 4, v1
    s_lshl_b32 s32, s28, 24
    s_lshl_b32 s33, s30, 27
    s_add_u32 s32, s32, s33
    s_lshl_b32 s33, s31, 17
    s_add_u32 s32, s32, s33
    s_add_u32 s32, s32, 14680064
    s_add_u32 s33, s29, s2
    s_lshl_b32 s33, s33, 13
    s_mov_b32 s38, 131072
    s_mov_b32 s39, 0x20000
    s_cmp_lt_u32 s3, 6
    s_cbranch_scc1 L_main
    s_barrier
    s_branch L_VL
L_main:
    s_sub_u32 s3, s3, 2
    v_bfe_u32 v6, v1, 2, 2
    v_lshlrev_b32 v2, 9, v6
    v_lshl_add_u32 v2, v4, 6, v2
    v_and_b32 v5, 3, v1
    v_lshl_add_u32 v2, v5, 4, v2
    s_lshl_b32 s34, s3, 11
    s_add_u32 s34, s34, s33
    s_waitcnt lgkmcnt(0)
    s_add_u32 s36, s6, s32
    s_addc_u32 s37, s7, 0
    s_barrier
    s_and_b32 s35, s34, 0x1ffff
    buffer_load_dwordx4 v[16:19], v2, s[36:39], s35 offen nt
    buffer_load_dwordx4 v[20:23], v2, s[36:39], s35 offen offset:256 nt
    s_add_u32 s34, s34, 8192
    s_and_b32 s35, s34, 0x1ffff
    buffer_load_dwordx4 v[24:27], v2, s[36:39], s35 offen nt
    buffer_load_dwordx4 v[28:31], v2, s[36:39], s35 offen offset:256 nt
    s_add_u32 s34, s34, 8192
    s_and_b32 s35, s34, 0x1ffff
    buffer_load_dwordx4 v[32:35], v2, s[36:39], s35 offen nt
    buffer_load_dwordx4 v[36:39], v2, s[36:39], s35 offen offset:256 nt
    s_add_u32 s34, s34, 8192
    s_and_b32 s35, s34, 0x1ffff
    buffer_load_dwordx4 v[40:43], v2, s[36:39], s35 offen nt
    buffer_load_dwordx4 v[44:47], v2, s[36:39], s35 offen offset:256 nt
    s_add_u32 s34, s34, 8192
    s_and_b32 s35, s34, 0x1ffff
    buffer_load_dwordx4 v[48:51], v2, s[36:39], s35 offen nt
    buffer_load_dwordx4 v[52:55], v2, s[36:39], s35 offen offset:256 nt
    s_add_u32 s34, s34, 8192
    s_and_b32 s35, s34, 0x1ffff
    buffer_load_dwordx4 v[56:59], v2, s[36:39], s35 offen nt
    buffer_load_dwordx4 v[60:63], v2, s[36:39], s35 offen offset:256 nt
    s_add_u32 s34, s34, 8192
    s_and_b32 s35, s34, 0x1ffff
    buffer_load_dwordx4 v[64:67], v2, s[36:39], s35 offen nt
    buffer_load_dwordx4 v[68:71], v2, s[36:39], s35 offen offset:256 nt
    s_add_u32 s34, s34, 8192
    s_and_b32 s35, s34, 0x1ffff
    buffer_load_dwordx4 v[72:75], v2, s[36:39], s35 offen nt
    buffer_load_dwordx4 v[76:79], v2, s[36:39], s35 offen offset:256 nt
    s_add_u32 s34, s34, 8192
    s_and_b32 s35, s34, 0x1ffff
    buffer_load_dwordx4 v[80:83], v2, s[36:39], s35 offen nt
    buffer_load_dwordx4 v[84:87], v2, s[36:39], s35 offen offset:256 nt
    s_add_u32 s34, s34, 8192
    s_and_b32 s35, s34, 0x1ffff
    buffer_load_dwordx4 v[88:91], v2, s[36:39], s35 offen nt
    buffer_load_dwordx4 v[92:95], v2, s[36:39], s35 offen offset:256 nt
    s_add_u32 s34, s34, 8192
    s_and_b32 s35, s34, 0x1ffff
    buffer_load_dwordx4 v[96:99], v2, s[36:39], s35 offen nt
    buffer_load_dwordx4 v[100:103], v2, s[36:39], s35 offen offset:256 nt
    s_add_u32 s34, s34, 8192
    s_and_b32 s35, s34, 0x1ffff
    buffer_load_dwordx4 v[104:107], v2, s[36:39], s35 offen nt
    buffer_load_dwordx4 v[108:111], v2, s[36:39], s35 offen offset:256 nt
    s_add_u32 s34, s34, 8192
    s_and_b32 s35, s34, 0x1ffff
    buffer_load_dwordx4 v[112:115], v2, s[36:39], s35 offen nt
    buffer_load_dwordx4 v[116:119], v2, s[36:39], s35 offen offset:256 nt
    s_add_u32 s34, s34, 8192
    s_and_b32 s35, s34, 0x1ffff
    buffer_load_dwordx4 v[120:123], v2, s[36:39], s35 offen nt
    buffer_load_dwordx4 v[124:127], v2, s[36:39], s35 offen offset:256 nt
    s_add_u32 s34, s34, 8192
    s_and_b32 s35, s34, 0x1ffff
    buffer_load_dwordx4 v[128:131], v2, s[36:39], s35 offen nt
    buffer_load_dwordx4 v[132:135], v2, s[36:39], s35 offen offset:256 nt
    s_add_u32 s34, s34, 8192
    s_and_b32 s35, s34, 0x1ffff
    buffer_load_dwordx4 v[136:139], v2, s[36:39], s35 offen nt
    buffer_load_dwordx4 v[140:143], v2, s[36:39], s35 offen offset:256 nt
    s_load_dword s60, s[26:27], 0
    s_mov_b32 s44, s26
    s_mov_b32 s45, s27
    s_mov_b32 s46, 1155072
    s_mov_b32 s47, 0x20000
    s_movk_i32 s62, 1023
    s_barrier
    v_and_b32 v5, 1, v1
    v_lshlrev_b32 v7, 9, v5
    v_lshl_add_u32 v7, v4, 6, v7
    v_lshl_add_u32 v7, v6, 4, v7
    v_add_u32 v7, 161536, v7
    v_lshrrev_b32 v8, 1, v6
    v_lshlrev_b32 v8, 5, v8
    v_and_b32 v11, 1, v6
    v_lshl_add_u32 v8, v11, 2, v8
    v_add_u32 v8, v8, v4
    s_lshl_b32 s34, s3, 3
    v_add_u32 v8, s34, v8
    v_lshlrev_b32 v8, 1, v8
    v_lshl_add_u32 v8, v5, 9, v8
    v_add_u32 v8, 161536, v8
    v_lshlrev_b32 v9, 9, v5
    v_lshl_add_u32 v9, v4, 4, v9
    v_add_u32 v9, 161536, v9
    v_lshlrev_b32 v10, 4, v5
    v_add_u32 v10, 162688, v10
    s_lshl_b32 s34, s3, 2
    v_add_u32 v12, s34, v10
    v_mov_b32 v3, 162720
    v_and_b32 v11, 1, v4
    v_lshl_add_u32 v11, v11, 2, v6
    v_xor_b32 v11, s34, v11
    v_lshlrev_b32 v11, 5, v11
    v_lshl_add_u32 v13, v4, 2, v6
    v_lshl_add_u32 v11, v13, 9, v11
    v_and_b32 v13, 3, v1
    v_lshl_add_u32 v176, v13, 3, v11
    v_xor_b32 v177, 32, v176
    v_xor_b32 v178, 64, v176
    v_xor_b32 v179, 0x60, v176
    v_add_u32 v13, s34, v6
    v_lshlrev_b32 v13, 11, v13
    v_lshl_add_u32 v13, v5, 15, v13
    v_lshl_add_u32 v14, v4, 8, v13
    s_lshl_b32 s48, s28, 16
    s_lshr_b32 s34, s29, 4
    s_lshl_b32 s34, s34, 10
    s_add_u32 s48, s48, s34
    s_and_b32 s34, s29, 15
    s_lshl_b32 s34, s34, 4
    s_add_u32 s48, s48, s34
    s_add_u32 s48, s48, 401408
    v_lshlrev_b32 v2, 11, v5
    s_lshl_b32 s49, s28, 12
    s_lshr_b32 s34, s31, 3
    s_lshl_b32 s34, s34, 10
    s_add_u32 s49, s49, s34
    s_lshl_b32 s34, s3, 8
    s_add_u32 s49, s49, s34
    s_and_b32 s34, s31, 7
    s_lshl_b32 s34, s34, 5
    s_add_u32 s49, s49, s34
    s_lshl_b32 s34, s30, 4
    s_add_u32 s49, s49, s34
    s_add_u32 s49, s49, 368640
    s_mov_b32 s50, 0x3db8aa3b
    v_mov_b32 v160, 0
    v_mov_b32 v161, 0
    v_mov_b32 v162, 0
    v_mov_b32 v163, 0
    v_mov_b32 v164, 0
    v_mov_b32 v165, 0
    v_mov_b32 v166, 0
    v_mov_b32 v167, 0
    v_mov_b32 v168, 0
    v_mov_b32 v169, 0
    v_mov_b32 v170, 0
    v_mov_b32 v171, 0
    v_mov_b32 v172, 0
    v_mov_b32 v173, 0
    v_mov_b32 v174, 0
    v_mov_b32 v175, 0
    s_movk_i32 s33, 20000
    s_waitcnt vmcnt(0) lgkmcnt(0)
    s_mov_b64 exec, 1
    s_branch L_mq1
L_mq:
    s_sleep 2
L_mq1:
    ds_read_b64 v[152:153], v3
    s_sub_u32 s33, s33, 1
    s_cbranch_scc1 L_mqd
    s_waitcnt lgkmcnt(0)
    v_readfirstlane_b32 s34, v152
    s_cmp_eq_u32 s34, 0
    s_cbranch_scc1 L_mq
L_mqd:
    s_waitcnt lgkmcnt(0)
    v_readfirstlane_b32 s61, v153
    s_mov_b64 exec, -1
    ds_read_b128 v[144:147], v7
    ds_read_b128 v[148:151], v7 offset:256
    s_add_u32 s60, s60, 1
    s_and_b32 s60, s60, 1023
    v_mov_b32 v15, s60
    s_waitcnt lgkmcnt(0)
    v_mfma_f32_16x16x32_bf16 v[152:155], v[16:19], v[144:147], 0
    v_mfma_f32_16x16x32_bf16 v[152:155], v[20:23], v[148:151], v[152:155]
    v_mfma_f32_16x16x32_bf16 v[16:19], v[48:51], v[144:147], 0
    v_mfma_f32_16x16x32_bf16 v[16:19], v[52:55], v[148:151], v[16:19]
    v_mfma_f32_16x16x32_bf16 v[48:51], v[80:83], v[144:147], 0
    v_mfma_f32_16x16x32_bf16 v[48:51], v[84:87], v[148:151], v[48:51]
    v_mfma_f32_16x16x32_bf16 v[80:83], v[112:115], v[144:147], 0
    v_mfma_f32_16x16x32_bf16 v[80:83], v[116:119], v[148:151], v[80:83]
    v_mfma_f32_16x16x32_bf16 v[112:115], v[24:27], v[144:147], 0
    v_mfma_f32_16x16x32_bf16 v[112:115], v[28:31], v[148:151], v[112:115]
    v_mfma_f32_16x16x32_bf16 v[24:27], v[56:59], v[144:147], 0
    v_mfma_f32_16x16x32_bf16 v[24:27], v[60:63], v[148:151], v[24:27]
    v_add_f32_dpp v156, v153, v152 row_ror:12 row_mask:0xf bank_mask:0x1
    v_add_f32_dpp v157, v17, v16 row_ror:12 row_mask:0xf bank_mask:0x1
    v_add_f32_dpp v158, v49, v48 row_ror:12 row_mask:0xf bank_mask:0x1
    v_mfma_f32_16x16x32_bf16 v[56:59], v[88:91], v[144:147], 0
    v_mfma_f32_16x16x32_bf16 v[56:59], v[92:95], v[148:151], v[56:59]
    v_add_f32_dpp v159, v81, v80 row_ror:12 row_mask:0xf bank_mask:0x1
    v_add_f32_dpp v156, v154, v156 row_ror:8 row_mask:0xf bank_mask:0x1
    v_add_f32_dpp v157, v18, v157 row_ror:8 row_mask:0xf bank_mask:0x1
    v_mfma_f32_16x16x32_bf16 v[88:91], v[120:123], v[144:147], 0
    v_mfma_f32_16x16x32_bf16 v[88:91], v[124:127], v[148:151], v[88:91]
    v_add_f32_dpp v158, v50, v158 row_ror:8 row_mask:0xf bank_mask:0x1
    v_add_f32_dpp v159, v82, v159 row_ror:8 row_mask:0xf bank_mask:0x1
    v_add_f32_dpp v156, v155, v156 row_ror:4 row_mask:0xf bank_mask:0x1
    v_mfma_f32_16x16x32_bf16 v[120:123], v[32:35], v[144:147], 0
    v_mfma_f32_16x16x32_bf16 v[120:123], v[36:39], v[148:151], v[120:123]
    v_add_f32_dpp v157, v19, v157 row_ror:4 row_mask:0xf bank_mask:0x1
    v_add_f32_dpp v158, v51, v158 row_ror:4 row_mask:0xf bank_mask:0x1
    v_add_f32_dpp v159, v83, v159 row_ror:4 row_mask:0xf bank_mask:0x1
    v_mfma_f32_16x16x32_bf16 v[32:35], v[64:67], v[144:147], 0
    v_mfma_f32_16x16x32_bf16 v[32:35], v[68:71], v[148:151], v[32:35]
    v_add_f32_dpp v156, v112, v113 row_ror:4 row_mask:0xf bank_mask:0x2
    v_add_f32_dpp v157, v24, v25 row_ror:4 row_mask:0xf bank_mask:0x2
    v_add_f32_dpp v158, v56, v57 row_ror:4 row_mask:0xf bank_mask:0x2
    v_mfma_f32_16x16x32_bf16 v[64:67], v[96:99], v[144:147], 0
    v_mfma_f32_16x16x32_bf16 v[64:67], v[100:103], v[148:151], v[64:67]
    v_add_f32_dpp v159, v88, v89 row_ror:4 row_mask:0xf bank_mask:0x2
    v_add_f32_dpp v156, v114, v156 row_ror:12 row_mask:0xf bank_mask:0x2
    v_add_f32_dpp v157, v26, v157 row_ror:12 row_mask:0xf bank_mask:0x2
    v_mfma_f32_16x16x32_bf16 v[96:99], v[128:131], v[144:147], 0
    v_mfma_f32_16x16x32_bf16 v[96:99], v[132:135], v[148:151], v[96:99]
    v_add_f32_dpp v158, v58, v158 row_ror:12 row_mask:0xf bank_mask:0x2
    v_add_f32_dpp v159, v90, v159 row_ror:12 row_mask:0xf bank_mask:0x2
    v_add_f32_dpp v156, v115, v156 row_ror:8 row_mask:0xf bank_mask:0x2
    v_mfma_f32_16x16x32_bf16 v[128:131], v[40:43], v[144:147], 0
    v_mfma_f32_16x16x32_bf16 v[128:131], v[44:47], v[148:151], v[128:131]
    v_add_f32_dpp v157, v27, v157 row_ror:8 row_mask:0xf bank_mask:0x2
    v_add_f32_dpp v158, v59, v158 row_ror:8 row_mask:0xf bank_mask:0x2
    v_add_f32_dpp v159, v91, v159 row_ror:8 row_mask:0xf bank_mask:0x2
    v_mfma_f32_16x16x32_bf16 v[40:43], v[72:75], v[144:147], 0
    v_mfma_f32_16x16x32_bf16 v[40:43], v[76:79], v[148:151], v[40:43]
    v_add_f32_dpp v156, v120, v122 row_ror:8 row_mask:0xf bank_mask:0x4
    v_add_f32_dpp v157, v32, v34 row_ror:8 row_mask:0xf bank_mask:0x4
    v_add_f32_dpp v158, v64, v66 row_ror:8 row_mask:0xf bank_mask:0x4
    v_mfma_f32_16x16x32_bf16 v[72:75], v[104:107], v[144:147], 0
    v_mfma_f32_16x16x32_bf16 v[72:75], v[108:111], v[148:151], v[72:75]
    v_add_f32_dpp v159, v96, v98 row_ror:8 row_mask:0xf bank_mask:0x4
    v_add_f32_dpp v156, v121, v156 row_ror:4 row_mask:0xf bank_mask:0x4
    v_add_f32_dpp v157, v33, v157 row_ror:4 row_mask:0xf bank_mask:0x4
    v_mfma_f32_16x16x32_bf16 v[104:107], v[136:139], v[144:147], 0
    v_mfma_f32_16x16x32_bf16 v[104:107], v[140:143], v[148:151], v[104:107]
    v_add_f32_dpp v158, v65, v158 row_ror:4 row_mask:0xf bank_mask:0x4
    v_add_f32_dpp v159, v97, v159 row_ror:4 row_mask:0xf bank_mask:0x4
    v_add_f32_dpp v156, v123, v156 row_ror:12 row_mask:0xf bank_mask:0x4
    v_add_f32_dpp v157, v35, v157 row_ror:12 row_mask:0xf bank_mask:0x4
    v_add_f32_dpp v158, v67, v158 row_ror:12 row_mask:0xf bank_mask:0x4
    v_add_f32_dpp v159, v99, v159 row_ror:12 row_mask:0xf bank_mask:0x4
    v_add_f32_dpp v156, v128, v131 row_ror:12 row_mask:0xf bank_mask:0x8
    v_add_f32_dpp v157, v40, v43 row_ror:12 row_mask:0xf bank_mask:0x8
    v_add_f32_dpp v158, v72, v75 row_ror:12 row_mask:0xf bank_mask:0x8
    v_add_f32_dpp v159, v104, v107 row_ror:12 row_mask:0xf bank_mask:0x8
    v_add_f32_dpp v156, v129, v156 row_ror:8 row_mask:0xf bank_mask:0x8
    v_add_f32_dpp v157, v41, v157 row_ror:8 row_mask:0xf bank_mask:0x8
    v_add_f32_dpp v158, v73, v158 row_ror:8 row_mask:0xf bank_mask:0x8
    v_add_f32_dpp v159, v105, v159 row_ror:8 row_mask:0xf bank_mask:0x8
    v_add_f32_dpp v156, v130, v156 row_ror:4 row_mask:0xf bank_mask:0x8
    v_add_f32_dpp v157, v42, v157 row_ror:4 row_mask:0xf bank_mask:0x8
    v_add_f32_dpp v158, v74, v158 row_ror:4 row_mask:0xf bank_mask:0x8
    v_add_f32_dpp v159, v106, v159 row_ror:4 row_mask:0xf bank_mask:0x8
    v_cvt_pk_bf16_f32 v5, v156, v157
    v_cvt_pk_bf16_f32 v6, v158, v159
    v_lshlrev_b32 v156, 16, v5
    v_and_b32 v157, 0xffff0000, v5
    v_lshlrev_b32 v158, 16, v6
    v_and_b32 v159, 0xffff0000, v6
    v_max3_f32 v5, v156, v157, v158
    v_max_f32 v5, v5, v159
    s_nop 1
    v_max_f32_dpp v5, v5, v5 row_ror:4 row_mask:0xf bank_mask:0xf
    s_nop 1
    v_max_f32_dpp v5, v5, v5 row_ror:8 row_mask:0xf bank_mask:0xf
    v_mov_b32 v6, v5
    s_nop 1
    v_permlane16_swap_b32 v6, v5
    v_max_f32 v5, v5, v6
    v_mov_b32 v6, v5
    s_nop 1
    v_permlane32_swap_b32 v6, v5
    v_max_f32 v5, v5, v6
    ds_write_b32 v12, v5
    s_movk_i32 s33, 20000
L_mx:
    ds_read_b128 v[152:155], v10
    s_sub_u32 s33, s33, 1
    s_cbranch_scc1 L_mxd
    s_waitcnt lgkmcnt(0)
    v_max3_u32 v5, v152, v153, v154
    v_max_u32 v5, v5, v155
    v_cmp_eq_u32 vcc, -1, v5
    s_cbranch_vccnz L_mx
L_mxd:
    s_waitcnt lgkmcnt(0)
    v_max3_f32 v5, v152, v153, v154
    v_max_f32 v5, v5, v155
    v_mul_f32 v5, s50, v5
    v_and_b32 v152, 0xfffffc00, v5
    v_fma_f32 v156, v156, s50, -v152
    v_fma_f32 v157, v157, s50, -v152
    v_fma_f32 v158, v158, s50, -v152
    v_fma_f32 v159, v159, s50, -v152
    v_exp_f32 v156, v156
    v_exp_f32 v157, v157
    v_exp_f32 v158, v158
    v_exp_f32 v159, v159
    s_lshl_b32 s34, s3, 2
    v_cvt_pk_bf16_f32 v5, v156, v157
    v_cvt_pk_bf16_f32 v6, v158, v159
    v_add_u32 v13, s34, v3
    v_mov_b32 v11, 1
    ds_write_b16 v8, v5
    ds_write_b16_d16_hi v8, v5 offset:128
    ds_write_b16 v8, v6 offset:256
    ds_write_b16_d16_hi v8, v6 offset:384
    ds_write_b32 v13, v11 offset:16
    v_add_f32 v153, v156, v157
    v_add_f32 v153, v153, v158
    v_add_f32 v153, v153, v159
    s_nop 1
    v_add_f32_dpp v153, v153, v153 row_ror:4 row_mask:0xf bank_mask:0xf
    s_nop 1
    v_add_f32_dpp v153, v153, v153 row_ror:8 row_mask:0xf bank_mask:0xf
    v_mov_b32 v6, v153
    s_nop 1
    v_permlane16_swap_b32 v6, v153
    v_add_f32 v153, v153, v6
    v_mov_b32 v6, v153
    s_nop 1
    v_permlane32_swap_b32 v6, v153
    v_add_f32 v153, v153, v6
    v_bfi_b32 v152, s62, v15, v152
    v_bfi_b32 v153, s62, v15, v153
    v_mov_b32 v154, v152
    v_mov_b32 v155, v153
    s_mov_b64 exec, 3
    s_cmp_eq_u32 s61, 0
    s_cbranch_scc1 L_sst_s
    buffer_store_dwordx4 v[152:155], v2, s[44:47], s49 offen
    s_branch L_sst_e
L_sst_s:
    buffer_store_dwordx4 v[152:155], v2, s[44:47], s49 offen sc1
L_sst_e:
    s_mov_b64 exec, -1
    s_movk_i32 s33, 20000
L_pr:
    ds_read_b128 v[156:159], v3 offset:16
    s_sub_u32 s33, s33, 1
    s_cbranch_scc1 L_prd
    s_waitcnt lgkmcnt(0)
    v_and_b32 v5, v156, v157
    v_and_b32 v6, v158, v159
    v_and_b32 v5, v5, v6
    v_cmp_eq_u32 vcc, 0, v5
    s_cbranch_vccnz L_pr
L_prd:
    s_mov_b32 s51, 0
    s_mov_b32 s52, 0
    s_movk_i32 s33, 20000
L_pv:
    ds_read_b128 v[48:51], v9
    s_cmp_lt_u32 s51, s52
    s_cbranch_scc1 L_pvgo
    s_mov_b64 exec, 1
L_pvw:
    ds_read_b64 v[156:157], v3 offset:32
    s_sub_u32 s33, s33, 1
    s_cbranch_scc1 L_pvx
    s_waitcnt lgkmcnt(0)
    v_min_u32 v5, v156, v157
    s_nop 0
    v_readfirstlane_b32 s52, v5
    s_cmp_lt_u32 s51, s52
    s_cbranch_scc1 L_pvx
    s_cmp_eq_u32 s51, 7
    s_cbranch_scc1 L_pvw
    s_sleep 2
    s_branch L_pvw
L_pvx:
    s_mov_b64 exec, -1
L_pvgo:
    ds_read_b64_tr_b16 v[16:17], v176
    ds_read_b64_tr_b16 v[18:19], v176 offset:8192
    ds_read_b64_tr_b16 v[20:21], v177
    ds_read_b64_tr_b16 v[22:23], v177 offset:8192
    ds_read_b64_tr_b16 v[24:25], v178
    ds_read_b64_tr_b16 v[26:27], v178 offset:8192
    ds_read_b64_tr_b16 v[28:29], v179
    ds_read_b64_tr_b16 v[30:31], v179 offset:8192
    s_add_u32 s51, s51, 1
    v_add_u32 v9, 64, v9
    v_add_u32 v176, 0x4000, v176
    v_add_u32 v177, 0x4000, v177
    v_add_u32 v178, 0x4000, v178
    v_add_u32 v179, 0x4000, v179
    s_waitcnt lgkmcnt(6)
    v_mfma_f32_16x16x32_bf16 v[160:163], v[16:19], v[48:51], v[160:163]
    s_waitcnt lgkmcnt(4)
    v_mfma_f32_16x16x32_bf16 v[164:167], v[20:23], v[48:51], v[164:167]
    s_waitcnt lgkmcnt(2)
    v_mfma_f32_16x16x32_bf16 v[168:171], v[24:27], v[48:51], v[168:171]
    s_waitcnt lgkmcnt(0)
    v_mfma_f32_16x16x32_bf16 v[172:175], v[28:31], v[48:51], v[172:175]
    s_cmp_lt_u32 s51, 8
    s_cbranch_scc1 L_pv
    v_mov_b32_dpp v160, v164 quad_perm:[0,1,2,3] row_mask:0xf bank_mask:0x2
    v_mov_b32_dpp v161, v165 quad_perm:[0,1,2,3] row_mask:0xf bank_mask:0x2
    v_mov_b32_dpp v162, v166 quad_perm:[0,1,2,3] row_mask:0xf bank_mask:0x2
    v_mov_b32_dpp v163, v167 quad_perm:[0,1,2,3] row_mask:0xf bank_mask:0x2
    v_mov_b32_dpp v160, v168 quad_perm:[0,1,2,3] row_mask:0xf bank_mask:0x4
    v_mov_b32_dpp v161, v169 quad_perm:[0,1,2,3] row_mask:0xf bank_mask:0x4
    v_mov_b32_dpp v162, v170 quad_perm:[0,1,2,3] row_mask:0xf bank_mask:0x4
    v_mov_b32_dpp v163, v171 quad_perm:[0,1,2,3] row_mask:0xf bank_mask:0x4
    v_mov_b32_dpp v160, v172 quad_perm:[0,1,2,3] row_mask:0xf bank_mask:0x8
    v_mov_b32_dpp v161, v173 quad_perm:[0,1,2,3] row_mask:0xf bank_mask:0x8
    v_mov_b32_dpp v162, v174 quad_perm:[0,1,2,3] row_mask:0xf bank_mask:0x8
    v_mov_b32_dpp v163, v175 quad_perm:[0,1,2,3] row_mask:0xf bank_mask:0x8
    v_bfi_b32 v160, s62, v15, v160
    v_bfi_b32 v161, s62, v15, v161
    v_bfi_b32 v162, s62, v15, v162
    v_bfi_b32 v163, s62, v15, v163
    s_mov_b32 exec_lo, 0x33333333
    s_mov_b32 exec_hi, 0x33333333
    s_cmp_eq_u32 s61, 0
    s_cbranch_scc1 L_sop_s
    buffer_store_dwordx4 v[160:163], v14, s[44:47], s48 offen
    s_branch L_sop_e
L_sop_s:
    buffer_store_dwordx4 v[160:163], v14, s[44:47], s48 offen sc1
L_sop_e:
    s_mov_b64 exec, 1
    ds_add_u32 v3, v11 offset:40
    s_mov_b64 exec, -1
    s_barrier
    s_branch L_fin
L_VL:
    v_lshlrev_b32 v5, 4, v1
    v_add_u32 v5, 162560, v5
    v_subrev_u32 v6, 8, v1
    v_cmp_gt_u32 vcc, 2, v6
    v_mov_b32 v7, 0
    s_mov_b32 exec_lo, 0x1fff
    s_mov_b32 exec_hi, 0
    v_cndmask_b32 v8, 0, -1, vcc
    v_mov_b32 v9, v8
    v_mov_b32 v10, v8
    v_mov_b32 v11, v8
    ds_write_b128 v5, v[8:11]
    s_mov_b64 exec, -1
    s_sub_u32 s40, s3, 6
    v_lshrrev_b32 v5, 5, v1
    v_and_b32 v7, 31, v1
    s_lshl_b32 s34, s40, 2
    v_lshl_or_b32 v6, v5, 1, s34
    v_xor_b32 v6, v6, v7
    v_lshlrev_b32 v2, 4, v6
    v_lshl_add_u32 v2, v5, 9, v2
    v_xor_b32 v3, 0x80, v2
    s_lshl_b32 s41, s40, 10
    s_add_u32 s34, s41, s33
    s_waitcnt lgkmcnt(0)
    s_add_u32 s36, s8, s32
    s_addc_u32 s37, s9, 0
    s_load_dword s60, s[26:27], 0
    s_mov_b32 s44, s26
    s_mov_b32 s45, s27
    s_mov_b32 s46, 1155072
    s_mov_b32 s47, 0x20000
    s_movk_i32 s62, 1023
    s_waitcnt lgkmcnt(0)
    s_add_u32 s60, s60, 1
    s_and_b32 s60, s60, 1023
    v_mov_b32 v15, s60
    s_min_u32 s35, s29, 6
    s_lshl_b32 s84, s35, 7
    s_lshr_b32 s33, s28, 2
    s_mul_i32 s33, s33, 896
    s_add_u32 s84, s84, s33
    s_and_b32 s33, s28, 3
    s_lshl_b32 s33, s33, 5
    s_add_u32 s84, s84, s33

    s_lshl_b32 s56, s2, 12
    s_add_u32 s56, s56, 925696
    s_mov_b32 s80, s4
    s_mov_b32 s81, s5
    s_movk_i32 s82, 1792
    s_mov_b32 s83, 0x20000
    v_and_b32 v10, 3, v1
    v_lshlrev_b32 v12, 3, v10
    v_lshl_add_u32 v12, v4, 1, v12
    v_mov_b32 v14, 0
    s_cmp_lg_u32 s3, 6
    s_cbranch_scc1 L_noid
    s_setprio 3
    s_getreg_b32 s35, hwreg(HW_REG_XCC_ID, 0, 4)
    s_lshl_b32 s35, s35, 16
    s_or_b32 s35, s35, s60
    v_mov_b32 v16, s35
    v_mov_b32 v17, s35
    v_mov_b32 v18, s35
    v_mov_b32 v19, s35
    v_mov_b32 v20, 0
    s_lshl_b32 s35, s28, 9
    s_lshl_b32 s33, s29, 4
    s_add_u32 s35, s35, s33
    s_add_u32 s35, s35, 1024
    s_mov_b64 exec, 1
    buffer_store_dwordx4 v[16:19], v20, s[44:47], s35 offen sc1
    s_mov_b64 exec, -1
    buffer_load_ushort v14, v12, s[80:83], s84 offen
    s_setprio 0
L_noid:
    s_lshr_b32 s33, s29, 3
    s_lshl_b32 s35, s28, 2
    s_add_u32 s35, s35, s33
    s_mul_i32 s35, s35, 114688
    s_and_b32 s43, s29, 7
    s_lshl_b32 s42, s43, 7
    s_add_u32 s35, s35, s42
    s_add_u32 s48, s12, s35
    s_addc_u32 s49, s13, 0
    s_cmp_lt_u32 s43, 7
    s_cselect_b32 s50, 114688, 0
    s_cselect_b32 s54, 57344, 0
    s_mov_b32 s51, 0x20000
    s_cmp_gt_u32 s28, 5
    s_cselect_b32 s35, 1, 0
    s_sub_u32 s35, s28, s35
    s_min_u32 s35, s35, 6
    s_lshl_b32 s35, s35, 2
    s_lshr_b32 s33, s29, 3
    s_add_u32 s35, s35, s33
    s_and_b32 s33, s29, 7
    s_mul_i32 s35, s35, 57344
    s_add_u32 s35, s35, s42
    s_add_u32 s52, s20, s35
    s_addc_u32 s53, s21, 0
    s_cmp_lg_u32 s28, 5
    s_cselect_b32 s54, s54, 0
    s_mov_b32 s55, 0x20000
    s_lshl_b32 s35, s40, 2
    v_mov_b32 v5, 162752
    v_add_u32 v5, s35, v5
    v_lshlrev_b32 v6, 4, v1
    v_and_b32 v7, 7, v1
    v_lshlrev_b32 v8, 1, v4
    v_xor_b32 v7, v7, v8
    v_lshrrev_b32 v9, 3, v1
    v_mul_u32_u24 v9, 896, v9
    v_lshl_add_u32 v9, v7, 4, v9
    s_mov_b32 s42, s41
    s_mul_i32 s41, s40, 7168
    s_mov_b32 s43, -2
    s_barrier
L_vl:
    s_and_b32 s35, s34, 0x1ffff
    s_mov_b32 m0, s42
    s_add_u32 s34, s34, 2048
    buffer_load_dwordx4 v2, s[36:39], s35 offen nt lds
    s_add_u32 s42, s42, 2048
    s_and_b32 s35, s34, 0x1ffff
    s_mov_b32 m0, s42
    s_add_u32 s34, s34, 2048
    buffer_load_dwordx4 v3, s[36:39], s35 offen nt lds
    s_add_u32 s42, s42, 2048
    s_and_b32 s35, s34, 0x1ffff
    s_mov_b32 m0, s42
    s_add_u32 s34, s34, 2048
    buffer_load_dwordx4 v2, s[36:39], s35 offen nt lds
    s_add_u32 s42, s42, 2048
    s_and_b32 s35, s34, 0x1ffff
    s_mov_b32 m0, s42
    s_add_u32 s34, s34, 2048
    buffer_load_dwordx4 v3, s[36:39], s35 offen nt lds
    s_add_u32 s42, s42, 2048
    s_and_b32 s35, s34, 0x1ffff
    s_mov_b32 m0, s42
    s_add_u32 s34, s34, 2048
    buffer_load_dwordx4 v2, s[36:39], s35 offen nt lds
    s_add_u32 s42, s42, 2048
    s_and_b32 s35, s34, 0x1ffff
    s_mov_b32 m0, s42
    s_add_u32 s34, s34, 2048
    buffer_load_dwordx4 v3, s[36:39], s35 offen nt lds
    s_add_u32 s42, s42, 2048
    s_and_b32 s35, s34, 0x1ffff
    s_mov_b32 m0, s42
    s_add_u32 s34, s34, 2048
    buffer_load_dwordx4 v2, s[36:39], s35 offen nt lds
    s_add_u32 s42, s42, 2048
    s_and_b32 s35, s34, 0x1ffff
    s_mov_b32 m0, s42
    s_add_u32 s34, s34, 2048
    buffer_load_dwordx4 v3, s[36:39], s35 offen nt lds
    s_add_u32 s42, s42, 2048
    s_max_i32 s35, s43, 0
    v_mov_b32 v7, s35
    s_waitcnt vmcnt(24)
    ds_write_b32 v5, v7
    s_add_u32 s43, s43, 1
    s_cmp_lt_u32 s42, 131072
    s_cbranch_scc1 L_vl
    v_mov_b32 v7, 6
    s_waitcnt vmcnt(16)
    ds_write_b32 v5, v7
    v_mov_b32 v7, 7
    s_waitcnt vmcnt(8)
    ds_write_b32 v5, v7
    s_mov_b32 m0, s42
    s_add_u32 s35, s41, 0
    buffer_load_dwordx4 v9, s[48:51], s35 offen nt lds
    s_add_u32 s42, s42, 2048
    s_mov_b32 m0, s42
    s_add_u32 s35, s41, 14336
    buffer_load_dwordx4 v9, s[48:51], s35 offen nt lds
    s_add_u32 s42, s42, 2048
    s_mov_b32 m0, s42
    s_add_u32 s35, s41, 28672
    buffer_load_dwordx4 v9, s[48:51], s35 offen nt lds
    s_add_u32 s42, s42, 2048
    s_mov_b32 m0, s42
    s_add_u32 s35, s41, 43008
    buffer_load_dwordx4 v9, s[48:51], s35 offen nt lds
    s_add_u32 s42, s42, 2048
    s_mov_b32 m0, s42
    s_add_u32 s35, s41, 57344
    buffer_load_dwordx4 v9, s[48:51], s35 offen nt lds
    s_add_u32 s42, s42, 2048
    s_mov_b32 m0, s42
    s_add_u32 s35, s41, 71680
    buffer_load_dwordx4 v9, s[48:51], s35 offen nt lds
    s_add_u32 s42, s42, 2048
    s_mov_b32 m0, s42
    s_add_u32 s35, s41, 86016
    buffer_load_dwordx4 v9, s[48:51], s35 offen nt lds
    s_add_u32 s42, s42, 2048
    s_mov_b32 m0, s42
    s_add_u32 s35, s41, 100352
    buffer_load_dwordx4 v9, s[48:51], s35 offen nt lds
    s_add_u32 s42, s42, 2048
    s_mov_b32 m0, s42
    s_add_u32 s35, s41, 0
    buffer_load_dwordx4 v9, s[52:55], s35 offen nt lds
    s_add_u32 s42, s42, 2048
    s_mov_b32 m0, s42
    s_add_u32 s35, s41, 14336
    buffer_load_dwordx4 v9, s[52:55], s35 offen nt lds
    s_add_u32 s42, s42, 2048
    s_mov_b32 m0, s42
    s_add_u32 s35, s41, 28672
    buffer_load_dwordx4 v9, s[52:55], s35 offen nt lds
    s_add_u32 s42, s42, 2048
    s_mov_b32 m0, s42
    s_add_u32 s35, s41, 43008
    buffer_load_dwordx4 v9, s[52:55], s35 offen nt lds
    v_mov_b32 v7, 8
    s_waitcnt vmcnt(12)
    ds_write_b32 v5, v7
    s_waitcnt vmcnt(0)
    s_barrier

    s_cmp_lg_u32 s40, 0
    s_cbranch_scc1 L_fin
    s_cmp_ge_u32 s2, 56
    s_cbranch_scc1 L_fin
    s_mov_b32 s80, s22
    s_mov_b32 s81, s23
    v_lshlrev_b32 v14, 16, v14
    s_barrier
    s_sleep 12
    s_movk_i32 s33, 5000
    buffer_load_dwordx4 v[32:35], v6, s[44:47], s56 offen offset:0 sc1
    buffer_load_dwordx4 v[36:39], v6, s[44:47], s56 offen offset:1024 sc1
    buffer_load_dwordx4 v[40:43], v6, s[44:47], s56 offen offset:2048 sc1
    buffer_load_dwordx4 v[44:47], v6, s[44:47], s56 offen offset:3072 sc1
L_fpoll:
    s_sleep 1
L_fpoll_e:
    buffer_load_dwordx4 v[48:51], v6, s[44:47], s56 offen offset:0 sc1
    buffer_load_dwordx4 v[52:55], v6, s[44:47], s56 offen offset:1024 sc1
    buffer_load_dwordx4 v[56:59], v6, s[44:47], s56 offen offset:2048 sc1
    buffer_load_dwordx4 v[60:63], v6, s[44:47], s56 offen offset:3072 sc1
    s_waitcnt vmcnt(7)
    v_xor_b32 v32, v15, v32
    v_xor_b32 v33, v15, v33
    v_xor_b32 v34, v15, v34
    v_xor_b32 v35, v15, v35
    v_or3_b32 v8, v32, v33, v34
    v_or_b32 v8, v8, v35
    s_waitcnt vmcnt(6)
    v_xor_b32 v36, v15, v36
    v_xor_b32 v37, v15, v37
    v_xor_b32 v38, v15, v38
    v_xor_b32 v39, v15, v39
    v_or3_b32 v8, v8, v36, v37
    v_or3_b32 v8, v8, v38, v39
    v_pk_add_f32 v[32:33], v[32:33], v[36:37]
    v_pk_add_f32 v[34:35], v[34:35], v[38:39]
    s_waitcnt vmcnt(5)
    v_xor_b32 v40, v15, v40
    v_xor_b32 v41, v15, v41
    v_xor_b32 v42, v15, v42
    v_xor_b32 v43, v15, v43
    v_or3_b32 v8, v8, v40, v41
    v_or3_b32 v8, v8, v42, v43
    s_waitcnt vmcnt(4)
    v_xor_b32 v44, v15, v44
    v_xor_b32 v45, v15, v45
    v_xor_b32 v46, v15, v46
    v_xor_b32 v47, v15, v47
    v_or3_b32 v8, v8, v44, v45
    v_or3_b32 v8, v8, v46, v47
    v_pk_add_f32 v[40:41], v[40:41], v[44:45]
    v_pk_add_f32 v[42:43], v[42:43], v[46:47]
    v_pk_add_f32 v[24:25], v[32:33], v[40:41]
    v_pk_add_f32 v[26:27], v[34:35], v[42:43]
    v_and_b32 v8, s62, v8
    v_cmp_eq_u32 vcc, 0, v8
    s_andn2_b64 s[92:93], exec, vcc
    s_mov_b64 exec, s[92:93]
    s_cbranch_execz L_fpoll_d
    s_sleep 1
    buffer_load_dwordx4 v[32:35], v6, s[44:47], s56 offen offset:0 sc1
    buffer_load_dwordx4 v[36:39], v6, s[44:47], s56 offen offset:1024 sc1
    buffer_load_dwordx4 v[40:43], v6, s[44:47], s56 offen offset:2048 sc1
    buffer_load_dwordx4 v[44:47], v6, s[44:47], s56 offen offset:3072 sc1
    s_waitcnt vmcnt(7)
    v_xor_b32 v48, v15, v48
    v_xor_b32 v49, v15, v49
    v_xor_b32 v50, v15, v50
    v_xor_b32 v51, v15, v51
    v_or3_b32 v8, v48, v49, v50
    v_or_b32 v8, v8, v51
    s_waitcnt vmcnt(6)
    v_xor_b32 v52, v15, v52
    v_xor_b32 v53, v15, v53
    v_xor_b32 v54, v15, v54
    v_xor_b32 v55, v15, v55
    v_or3_b32 v8, v8, v52, v53
    v_or3_b32 v8, v8, v54, v55
    v_pk_add_f32 v[48:49], v[48:49], v[52:53]
    v_pk_add_f32 v[50:51], v[50:51], v[54:55]
    s_waitcnt vmcnt(5)
    v_xor_b32 v56, v15, v56
    v_xor_b32 v57, v15, v57
    v_xor_b32 v58, v15, v58
    v_xor_b32 v59, v15, v59
    v_or3_b32 v8, v8, v56, v57
    v_or3_b32 v8, v8, v58, v59
    s_waitcnt vmcnt(4)
    v_xor_b32 v60, v15, v60
    v_xor_b32 v61, v15, v61
    v_xor_b32 v62, v15, v62
    v_xor_b32 v63, v15, v63
    v_or3_b32 v8, v8, v60, v61
    v_or3_b32 v8, v8, v62, v63
    v_pk_add_f32 v[56:57], v[56:57], v[60:61]
    v_pk_add_f32 v[58:59], v[58:59], v[62:63]
    v_pk_add_f32 v[24:25], v[48:49], v[56:57]
    v_pk_add_f32 v[26:27], v[50:51], v[58:59]
    v_and_b32 v8, s62, v8
    v_cmp_eq_u32 vcc, 0, v8
    s_andn2_b64 s[92:93], exec, vcc
    s_mov_b64 exec, s[92:93]
    s_cbranch_execz L_fpoll_d
    s_sub_u32 s33, s33, 1
    s_cbranch_scc0 L_fpoll
L_fpoll_d:
    s_mov_b64 exec, -1
    v_permlane32_swap_b32 v24, v26
    v_permlane32_swap_b32 v25, v27
    v_add_f32 v24, v24, v26
    v_add_f32 v25, v25, v27
    s_nop 1
    v_permlane16_swap_b32 v24, v25
    v_add_f32 v24, v24, v25
    s_nop 1
    v_add_f32_dpp v24, v24, v24 row_ror:4 row_mask:0xf bank_mask:0xf
    s_nop 1
    v_add_f32_dpp v24, v24, v24 row_ror:8 row_mask:0xf bank_mask:0xf
    v_add_f32 v24, v24, v14
    v_cvt_pk_bf16_f32 v24, v24, v24
    s_mov_b32 exec_lo, 0x000f000f
    s_mov_b32 exec_hi, 0x000f000f
    buffer_store_short v24, v12, s[80:83], s84 offen
    s_cmp_lg_u32 s2, 0
    s_cbranch_scc1 L_fin
    s_mov_b64 exec, 1
    buffer_store_dword v15, v12, s[44:47], 0 offen sc1
    s_branch L_fin
L_fin:
L_end:
    s_endpgm
.section .rodata,"a"
.p2align 6
.amdhsa_kernel parallel_sum__sliding_block_cached__glu_gated_reglu__decode_kernel
  .amdhsa_next_free_vgpr 180
  .amdhsa_next_free_sgpr 96
  .amdhsa_accum_offset 180
  .amdhsa_group_segment_fixed_size 0
  .amdhsa_kernarg_size 96
  .amdhsa_user_sgpr_count 2
  .amdhsa_user_sgpr_kernarg_segment_ptr 1
  .amdhsa_system_sgpr_workgroup_id_x 1
.end_amdhsa_kernel
```
